```python
import torch

def _softmax(x, axis=-1):
    return torch.softmax(x, dim=axis)
def _gelu(x):
    return torch.nn.functional.gelu(x, approximate="tanh")
def _silu(x):
    return torch.nn.functional.silu(x)
def _sigmoid(x):
    return torch.sigmoid(x)
def _layernorm(x, axis=-1, eps=1e-5):
    m = x.mean(dim=axis, keepdim=True)
    v = x.var(dim=axis, keepdim=True, unbiased=False)
    return (x - m) / torch.sqrt(v + eps)
def _scatter_add(tgt, idx, src, axis=0):
    return tgt.clone().index_add_(axis, idx, src)
def _segment_sum(src, seg, n):
    out = torch.zeros((n,) + src.shape[1:], dtype=src.dtype)
    return out.index_add_(0, seg, src)
def _pad(x, pw):
    flat = tuple(v for pair in reversed(pw) for v in pair)
    return torch.nn.functional.pad(x, flat)

kernel_name = 'parallel_sum__mha_block__dense_activation_relu__prompt'

def setup_inputs():

    _w = (lambda a: (lambda t: t.to(torch.bfloat16) if t.is_floating_point() else t)(torch.as_tensor(a)))
    def _A_setup():
        B, S, D, H = 1, 2048, 1024, 32
        return {
            "x": _w((lambda *s: torch.randn(*s, dtype=torch.bfloat16) * 0.05)(B, S, D)),
            "wqkv": _w((lambda *s: torch.randn(*s, dtype=torch.bfloat16) * 0.05)(D, 3 * D)),
            "wo": _w((lambda *s: torch.randn(*s, dtype=torch.bfloat16) * 0.05)(D, D)),
        }
    _A_in = _A_setup()

    def _B_setup():
        B, S, D, Dff = 1, 2048, 1024, 3584
        return {
            "x": _w((lambda *s: torch.randn(*s, dtype=torch.bfloat16) * 0.05)(B, S, D)),
            "w1": _w((lambda *s: torch.randn(*s, dtype=torch.bfloat16) * 0.05)(D, Dff)),
            "w2": _w((lambda *s: torch.randn(*s, dtype=torch.bfloat16) * 0.05)(Dff, D)),
        }
    _B_in = _B_setup()

    return {
        "A_x": _A_in["x"],
        "A_wqkv": _A_in["wqkv"],
        "A_wo": _A_in["wo"],
        "B_x": _B_in["x"],
        "B_w1": _B_in["w1"],
        "B_w2": _B_in["w2"],
    }

def reference(A_x, A_wqkv, A_wo, B_x, B_w1, B_w2):
    def _A_ref(x, wqkv, wo):
        B, S, D = x.shape
        H = 32
        Dh = D // H
        qkv = (lambda x, *d: x.permute(*d))((x @ wqkv).reshape(B, S, 3, H, Dh), 2, 0, 3, 1, 4)
        q, k, v = qkv[0], qkv[1], qkv[2]
        scores = torch.einsum("bhqd,bhkd->bhqk", q, k) * (Dh ** -0.5)
        p = _softmax(scores, axis=-1)
        o = torch.einsum("bhqk,bhkd->bhqd", p, v)
        return (lambda x, *d: x.permute(*d))(o, 0, 2, 1, 3).reshape(B, S, D) @ wo

    def _B_ref(x, w1, w2):
        h = torch.einsum("bsd,df->bsf", x, w1)
        zero = torch.zeros_like(h)
        h = torch.maximum(h, zero)
        return torch.einsum("bsf,fd->bsd", h, w2)

    x = A_x
    xn = _layernorm(x, axis=-1)
    return x + _A_ref(xn, A_wqkv, A_wo) + _B_ref(xn, B_w1, B_w2)
```

```asm
; @launch kernel=ln_kernel grid=(512,1,1) block=(256,1,1) lds=0
; @launch kernel=gemm1_kernel grid=(256,1,1) block=(512,1,1) lds=131072
; @launch kernel=mid_kernel grid=(768,1,1) block=(256,1,1) lds=65536
; @launch kernel=final_kernel grid=(256,1,1) block=(256,1,1) lds=98304
.amdgcn_target "amdgcn-amd-amdhsa--gfx950"
.text
.globl ln_kernel
.p2align 8
.type ln_kernel,@function
ln_kernel:
    s_load_dwordx16 s[64:79], s[0:1], 0
    s_load_dwordx2 s[80:81], s[0:1], 64
    s_cmp_ge_u32 s2, 512
    s_cbranch_scc1 ln_kernel_end
    v_lshrrev_b32 v1, 6, v0
    v_and_b32 v2, 63, v0
    s_lshl_b32 s3, s2, 2
    v_add_u32 v1, s3, v1
    v_lshlrev_b32 v1, 11, v1
    v_lshl_add_u32 v1, v2, 4, v1
    s_waitcnt lgkmcnt(0)
    s_mov_b32 s8, s64
    s_mov_b32 s9, s65
    s_and_b32 s9, s9, 0xffff
    s_mov_b32 s10, 0x400000
    s_mov_b32 s11, 0x00020000
    s_mov_b32 s12, s80
    s_mov_b32 s13, s81
    s_and_b32 s13, s13, 0xffff
    s_mov_b32 s14, 0x400000
    s_mov_b32 s15, 0x00020000
    buffer_load_dwordx4 v[4:7], v1, s[8:11], 0 offen
    buffer_load_dwordx4 v[8:11], v1, s[8:11], 0 offen offset:1024
    s_lshl_b32 s4, s2, 8
    v_add_u32 v88, s4, v0
    v_lshlrev_b32 v88, 4, v88
    v_add_u32 v89, 0x200000, v88
    v_add_u32 v90, 0x400000, v88
    v_add_u32 v91, 0x600000, v88
    s_mov_b32 s16, s66
    s_mov_b32 s17, s67
    s_and_b32 s17, s17, 0xffff
    s_mov_b32 s18, 0x600000
    s_mov_b32 s19, 0x00020000
    s_mov_b32 s20, s72
    s_mov_b32 s21, s73
    s_and_b32 s21, s21, 0xffff
    s_mov_b32 s22, 0x700000
    s_mov_b32 s23, 0x00020000
    s_mov_b32 s24, s74
    s_mov_b32 s25, s75
    s_and_b32 s25, s25, 0xffff
    s_mov_b32 s26, 0x700000
    s_mov_b32 s27, 0x00020000
    s_mov_b32 s28, s68
    s_mov_b32 s29, s69
    s_and_b32 s29, s29, 0xffff
    s_mov_b32 s30, 0x200000
    s_mov_b32 s31, 0x00020000
    buffer_load_dwordx4 v[40:43], v88, s[16:19], 0 offen
    buffer_load_dwordx4 v[44:47], v89, s[16:19], 0 offen
    buffer_load_dwordx4 v[48:51], v90, s[16:19], 0 offen
    buffer_load_dwordx4 v[52:55], v88, s[20:23], 0 offen
    buffer_load_dwordx4 v[56:59], v89, s[20:23], 0 offen
    buffer_load_dwordx4 v[60:63], v90, s[20:23], 0 offen
    buffer_load_dwordx4 v[64:67], v91, s[20:23], 0 offen
    s_waitcnt vmcnt(7)
    v_lshlrev_b32 v16, 16, v4
    v_and_b32 v17, 0xffff0000, v4
    v_lshlrev_b32 v18, 16, v5
    v_and_b32 v19, 0xffff0000, v5
    v_lshlrev_b32 v20, 16, v6
    v_and_b32 v21, 0xffff0000, v6
    v_lshlrev_b32 v22, 16, v7
    v_and_b32 v23, 0xffff0000, v7
    v_lshlrev_b32 v24, 16, v8
    v_and_b32 v25, 0xffff0000, v8
    v_lshlrev_b32 v26, 16, v9
    v_and_b32 v27, 0xffff0000, v9
    v_lshlrev_b32 v28, 16, v10
    v_and_b32 v29, 0xffff0000, v10
    v_lshlrev_b32 v30, 16, v11
    v_and_b32 v31, 0xffff0000, v11
    v_add_f32 v32, v16, v17
    v_add_f32 v32, v32, v18
    v_add_f32 v32, v32, v19
    v_add_f32 v32, v32, v20
    v_add_f32 v32, v32, v21
    v_add_f32 v32, v32, v22
    v_add_f32 v32, v32, v23
    v_add_f32 v32, v32, v24
    v_add_f32 v32, v32, v25
    v_add_f32 v32, v32, v26
    v_add_f32 v32, v32, v27
    v_add_f32 v32, v32, v28
    v_add_f32 v32, v32, v29
    v_add_f32 v32, v32, v30
    v_add_f32 v32, v32, v31
    ds_swizzle_b32 v33, v32 offset:0x41f
    s_waitcnt lgkmcnt(0)
    v_add_f32 v32, v32, v33
    ds_swizzle_b32 v33, v32 offset:0x81f
    s_waitcnt lgkmcnt(0)
    v_add_f32 v32, v32, v33
    ds_swizzle_b32 v33, v32 offset:0x101f
    s_waitcnt lgkmcnt(0)
    v_add_f32 v32, v32, v33
    ds_swizzle_b32 v33, v32 offset:0x201f
    s_waitcnt lgkmcnt(0)
    v_add_f32 v32, v32, v33
    ds_swizzle_b32 v33, v32 offset:0x401f
    s_waitcnt lgkmcnt(0)
    v_add_f32 v32, v32, v33
    s_nop 0
    v_readlane_b32 s20, v32, 0
    v_readlane_b32 s21, v32, 32
    s_nop 1
    v_mov_b32 v32, s20
    v_add_f32 v32, s21, v32
    v_mul_f32 v32, 0x3a800000, v32
    v_sub_f32 v34, v16, v32
    v_mul_f32 v35, v34, v34
    v_sub_f32 v34, v17, v32
    v_fmac_f32 v35, v34, v34
    v_sub_f32 v34, v18, v32
    v_fmac_f32 v35, v34, v34
    v_sub_f32 v34, v19, v32
    v_fmac_f32 v35, v34, v34
    v_sub_f32 v34, v20, v32
    v_fmac_f32 v35, v34, v34
    v_sub_f32 v34, v21, v32
    v_fmac_f32 v35, v34, v34
    v_sub_f32 v34, v22, v32
    v_fmac_f32 v35, v34, v34
    v_sub_f32 v34, v23, v32
    v_fmac_f32 v35, v34, v34
    v_sub_f32 v34, v24, v32
    v_fmac_f32 v35, v34, v34
    v_sub_f32 v34, v25, v32
    v_fmac_f32 v35, v34, v34
    v_sub_f32 v34, v26, v32
    v_fmac_f32 v35, v34, v34
    v_sub_f32 v34, v27, v32
    v_fmac_f32 v35, v34, v34
    v_sub_f32 v34, v28, v32
    v_fmac_f32 v35, v34, v34
    v_sub_f32 v34, v29, v32
    v_fmac_f32 v35, v34, v34
    v_sub_f32 v34, v30, v32
    v_fmac_f32 v35, v34, v34
    v_sub_f32 v34, v31, v32
    v_fmac_f32 v35, v34, v34
    ds_swizzle_b32 v33, v35 offset:0x41f
    s_waitcnt lgkmcnt(0)
    v_add_f32 v35, v35, v33
    ds_swizzle_b32 v33, v35 offset:0x81f
    s_waitcnt lgkmcnt(0)
    v_add_f32 v35, v35, v33
    ds_swizzle_b32 v33, v35 offset:0x101f
    s_waitcnt lgkmcnt(0)
    v_add_f32 v35, v35, v33
    ds_swizzle_b32 v33, v35 offset:0x201f
    s_waitcnt lgkmcnt(0)
    v_add_f32 v35, v35, v33
    ds_swizzle_b32 v33, v35 offset:0x401f
    s_waitcnt lgkmcnt(0)
    v_add_f32 v35, v35, v33
    s_nop 0
    v_readlane_b32 s20, v35, 0
    v_readlane_b32 s21, v35, 32
    s_nop 1
    v_mov_b32 v35, s20
    v_add_f32 v35, s21, v35
    v_mul_f32 v35, 0x3a800000, v35
    v_cvt_pk_bf16_f32 v33, v35, v35
    v_lshlrev_b32 v35, 16, v33
    v_cvt_pk_bf16_f32 v33, v32, v32
    v_lshlrev_b32 v32, 16, v33
    v_add_f32 v35, 0x3727c5ac, v35
    v_cvt_pk_bf16_f32 v33, v35, v35
    v_lshlrev_b32 v35, 16, v33
    v_sqrt_f32 v35, v35
    s_nop 0
    v_cvt_pk_bf16_f32 v33, v35, v35
    v_lshlrev_b32 v35, 16, v33
    v_rcp_f32 v35, v35
    s_nop 0
    v_sub_f32 v16, v16, v32
    v_sub_f32 v17, v17, v32
    v_sub_f32 v18, v18, v32
    v_sub_f32 v19, v19, v32
    v_sub_f32 v20, v20, v32
    v_sub_f32 v21, v21, v32
    v_sub_f32 v22, v22, v32
    v_sub_f32 v23, v23, v32
    v_sub_f32 v24, v24, v32
    v_sub_f32 v25, v25, v32
    v_sub_f32 v26, v26, v32
    v_sub_f32 v27, v27, v32
    v_sub_f32 v28, v28, v32
    v_sub_f32 v29, v29, v32
    v_sub_f32 v30, v30, v32
    v_sub_f32 v31, v31, v32
    v_cvt_pk_bf16_f32 v33, v16, v17
    v_lshlrev_b32 v16, 16, v33
    v_and_b32 v17, 0xffff0000, v33
    v_mul_f32 v16, v16, v35
    v_mul_f32 v17, v17, v35
    v_cvt_pk_bf16_f32 v4, v16, v17
    v_cvt_pk_bf16_f32 v33, v18, v19
    v_lshlrev_b32 v18, 16, v33
    v_and_b32 v19, 0xffff0000, v33
    v_mul_f32 v18, v18, v35
    v_mul_f32 v19, v19, v35
    v_cvt_pk_bf16_f32 v5, v18, v19
    v_cvt_pk_bf16_f32 v33, v20, v21
    v_lshlrev_b32 v20, 16, v33
    v_and_b32 v21, 0xffff0000, v33
    v_mul_f32 v20, v20, v35
    v_mul_f32 v21, v21, v35
    v_cvt_pk_bf16_f32 v6, v20, v21
    v_cvt_pk_bf16_f32 v33, v22, v23
    v_lshlrev_b32 v22, 16, v33
    v_and_b32 v23, 0xffff0000, v33
    v_mul_f32 v22, v22, v35
    v_mul_f32 v23, v23, v35
    v_cvt_pk_bf16_f32 v7, v22, v23
    v_cvt_pk_bf16_f32 v33, v24, v25
    v_lshlrev_b32 v24, 16, v33
    v_and_b32 v25, 0xffff0000, v33
    v_mul_f32 v24, v24, v35
    v_mul_f32 v25, v25, v35
    v_cvt_pk_bf16_f32 v8, v24, v25
    v_cvt_pk_bf16_f32 v33, v26, v27
    v_lshlrev_b32 v26, 16, v33
    v_and_b32 v27, 0xffff0000, v33
    v_mul_f32 v26, v26, v35
    v_mul_f32 v27, v27, v35
    v_cvt_pk_bf16_f32 v9, v26, v27
    v_cvt_pk_bf16_f32 v33, v28, v29
    v_lshlrev_b32 v28, 16, v33
    v_and_b32 v29, 0xffff0000, v33
    v_mul_f32 v28, v28, v35
    v_mul_f32 v29, v29, v35
    v_cvt_pk_bf16_f32 v10, v28, v29
    v_cvt_pk_bf16_f32 v33, v30, v31
    v_lshlrev_b32 v30, 16, v33
    v_and_b32 v31, 0xffff0000, v33
    v_mul_f32 v30, v30, v35
    v_mul_f32 v31, v31, v35
    v_cvt_pk_bf16_f32 v11, v30, v31
    buffer_store_dwordx4 v[4:7], v1, s[12:15], 0 offen
    buffer_store_dwordx4 v[8:11], v1, s[12:15], 0 offen offset:1024
    s_waitcnt vmcnt(0)
ln_kernel_end:
    s_endpgm
.section .rodata,"a"
.p2align 6
.amdhsa_kernel ln_kernel
  .amdhsa_next_free_vgpr 92
  .amdhsa_next_free_sgpr 100
  .amdhsa_accum_offset 92
  .amdhsa_group_segment_fixed_size 0
  .amdhsa_kernarg_size 72
  .amdhsa_user_sgpr_count 2
  .amdhsa_user_sgpr_kernarg_segment_ptr 1
  .amdhsa_system_sgpr_workgroup_id_x 1
.end_amdhsa_kernel
.text
.globl gemm1_kernel
.p2align 8
.type gemm1_kernel,@function
gemm1_kernel:
    s_load_dwordx16 s[64:79], s[0:1], 0
    s_load_dwordx2 s[80:81], s[0:1], 64
    s_cmp_ge_u32 s2, 256
    s_cbranch_scc1 gemm1_kernel_end
    s_waitcnt lgkmcnt(0)
    s_cmp_lt_u32 s2, 208
    s_cbranch_scc1 gemm1_kernel_main
    s_sub_u32 s4, s2, 208
    s_lshl_b32 s4, s4, 9
    v_add_u32 v1, s4, v0
    v_lshlrev_b32 v1, 4, v1
    s_mov_b32 s24, s74
    s_mov_b32 s25, s75
    s_and_b32 s25, s25, 0xffff
    s_mov_b32 s26, 0x700000
    s_mov_b32 s27, 0x00020000
    s_mov_b32 s28, s68
    s_mov_b32 s29, s69
    s_and_b32 s29, s29, 0xffff
    s_mov_b32 s30, 0x200000
    s_mov_b32 s31, 0x00020000
    v_add_u32 v2, 0x0, v1
    buffer_load_dwordx4 v[40:43], v2, s[24:27], 0 offen
    v_add_u32 v3, 0x60000, v1
    buffer_load_dwordx4 v[44:47], v3, s[24:27], 0 offen
    v_add_u32 v4, 0xc0000, v1
    buffer_load_dwordx4 v[48:51], v4, s[24:27], 0 offen
    v_add_u32 v5, 0x120000, v1
    buffer_load_dwordx4 v[52:55], v5, s[24:27], 0 offen
    v_add_u32 v6, 0x180000, v1
    buffer_load_dwordx4 v[56:59], v6, s[24:27], 0 offen
    v_add_u32 v7, 0x1e0000, v1
    buffer_load_dwordx4 v[60:63], v7, s[24:27], 0 offen
    v_add_u32 v8, 0x240000, v1
    buffer_load_dwordx4 v[64:67], v8, s[24:27], 0 offen
    v_add_u32 v9, 0x2a0000, v1
    buffer_load_dwordx4 v[68:71], v9, s[24:27], 0 offen
    v_add_u32 v10, 0x300000, v1
    buffer_load_dwordx4 v[72:75], v10, s[24:27], 0 offen
    v_add_u32 v11, 0x360000, v1
    buffer_load_dwordx4 v[76:79], v11, s[24:27], 0 offen
    v_add_u32 v12, 0x3c0000, v1
    buffer_load_dwordx4 v[80:83], v12, s[24:27], 0 offen
    v_add_u32 v13, 0x420000, v1
    buffer_load_dwordx4 v[84:87], v13, s[24:27], 0 offen
    v_add_u32 v14, 0x480000, v1
    buffer_load_dwordx4 v[88:91], v14, s[24:27], 0 offen
    v_add_u32 v15, 0x4e0000, v1
    buffer_load_dwordx4 v[92:95], v15, s[24:27], 0 offen
    v_add_u32 v16, 0x540000, v1
    buffer_load_dwordx4 v[96:99], v16, s[24:27], 0 offen
    v_add_u32 v17, 0x5a0000, v1
    buffer_load_dwordx4 v[100:103], v17, s[24:27], 0 offen
    v_add_u32 v18, 0x600000, v1
    buffer_load_dwordx4 v[104:107], v18, s[24:27], 0 offen
    v_add_u32 v19, 0x660000, v1
    buffer_load_dwordx4 v[108:111], v19, s[24:27], 0 offen
    v_add_u32 v20, 0x6c0000, v1
    buffer_load_dwordx4 v[112:115], v20, s[24:27], 0 offen
    v_add_u32 v21, 0x0, v1
    buffer_load_dwordx4 v[116:119], v21, s[28:31], 0 offen
    v_add_u32 v22, 0x60000, v1
    buffer_load_dwordx4 v[120:123], v22, s[28:31], 0 offen
    v_add_u32 v23, 0xc0000, v1
    buffer_load_dwordx4 v[124:127], v23, s[28:31], 0 offen
    v_add_u32 v24, 0x120000, v1
    buffer_load_dwordx4 v[128:131], v24, s[28:31], 0 offen
    v_add_u32 v25, 0x180000, v1
    buffer_load_dwordx4 v[132:135], v25, s[28:31], 0 offen
    v_add_u32 v26, 0x1e0000, v1
    buffer_load_dwordx4 v[136:139], v26, s[28:31], 0 offen
    s_waitcnt vmcnt(0)
    s_endpgm
gemm1_kernel_main:
    v_lshrrev_b32 v1, 6, v0
    v_and_b32 v0, 63, v0
    s_nop 0
    v_readfirstlane_b32 s4, v1
    s_cmp_ge_u32 s4, 4
    s_cbranch_scc1 gemm1_kernel_pr1
    s_setprio 2
gemm1_kernel_pr1:
    s_and_b32 s23, s2, 7
    s_mul_i32 s23, s23, 26
    s_lshr_b32 s24, s2, 3
    s_add_u32 s24, s24, s23
    s_and_b32 s23, s24, 7
    s_lshl_b32 s23, s23, 8
    s_lshr_b32 s24, s24, 3
    s_lshl_b32 s24, s24, 8
    s_mov_b32 s8, s80
    s_mov_b32 s9, s81
    s_and_b32 s9, s9, 0xffff
    s_mov_b32 s10, 0x400000
    s_mov_b32 s11, 0x00020000
    s_mov_b32 s36, 0
    s_mov_b32 s37, 0
    s_mov_b32 s38, 1.0
    s_cmp_ge_u32 s24, 3072
    s_cbranch_scc1 gemm1_kernel_ffn2
    s_mov_b32 s12, s66
    s_mov_b32 s13, s67
    s_and_b32 s13, s13, 0xffff
    s_mov_b32 s14, 0x600000
    s_mov_b32 s15, 0x00020000
    s_add_u32 s16, s80, 0x400000
    s_addc_u32 s17, s81, 0
    s_and_b32 s17, s17, 0xffff
    s_mov_b32 s18, 0xc00000
    s_mov_b32 s19, 0x00020000
    s_mov_b32 s20, 6144
    s_mov_b32 s21, 6144
    s_mov_b32 s22, 0xff800000
    s_mov_b32 s25, s24
    s_cmp_lt_u32 s24, 1024
    s_cselect_b32 s38, 0x3e8293ee, s38
    s_branch gemm1_kernel_j3
gemm1_kernel_ffn2:
    s_mov_b32 s12, s72
    s_mov_b32 s13, s73
    s_and_b32 s13, s13, 0xffff
    s_mov_b32 s14, 0x700000
    s_mov_b32 s15, 0x00020000
    s_add_u32 s16, s80, 0x1000000
    s_addc_u32 s17, s81, 0
    s_and_b32 s17, s17, 0xffff
    s_mov_b32 s18, 0x1200000
    s_mov_b32 s19, 0x00020000
    s_mov_b32 s20, 7168
    s_mov_b32 s21, 9216
    s_mov_b32 s22, 0
    s_sub_u32 s24, s24, 3072
    s_add_u32 s25, s24, 1024
gemm1_kernel_j3:
    s_lshr_b32 s5, s4, 1
    s_and_b32 s6, s4, 1
    v_lshrrev_b32 v3, 3, v0
    s_lshl_b32 s7, s4, 3
    s_add_u32 s7, s7, s23
    v_add_u32 v3, s7, v3
    s_mov_b32 s7, 2048
    v_mul_lo_u32 v2, v3, s7
    s_and_b32 s7, s4, 1
    s_lshl_b32 s7, s7, 2
    v_lshrrev_b32 v3, 4, v0
    v_add_u32 v3, s7, v3
    v_and_b32 v3, 7, v3
    v_and_b32 v4, 7, v0
    v_xor_b32 v3, v3, v4
    v_lshl_add_u32 v2, v3, 4, v2
    v_lshrrev_b32 v4, 5, v0
    s_mul_i32 s7, s4, 2
    v_add_u32 v4, s7, v4
    v_mul_lo_u32 v3, v4, s20
    v_and_b32 v4, 3, v4
    v_lshlrev_b32 v4, 2, v4
    v_and_b32 v5, 31, v0
    v_xor_b32 v4, v4, v5
    v_lshl_add_u32 v3, v4, 4, v3
    s_lshl_b32 s7, s24, 1
    v_add_u32 v3, s7, v3
    v_and_b32 v12, 31, v0
    v_lshrrev_b32 v13, 5, v0
    s_mul_i32 s7, s5, 8192
    v_lshlrev_b32 v14, 7, v12
    v_add_u32 v14, s7, v14
    v_lshrrev_b32 v15, 1, v0
    v_and_b32 v15, 7, v15
    v_add_u32 v16, 0, v13
    v_xor_b32 v16, v16, v15
    v_lshl_add_u32 v4, v16, 4, v14
    v_add_u32 v16, 2, v13
    v_xor_b32 v16, v16, v15
    v_lshl_add_u32 v5, v16, 4, v14
    v_add_u32 v16, 4, v13
    v_xor_b32 v16, v16, v15
    v_lshl_add_u32 v6, v16, 4, v14
    v_add_u32 v16, 6, v13
    v_xor_b32 v16, v16, v15
    v_lshl_add_u32 v7, v16, 4, v14
    v_lshrrev_b32 v14, 2, v0
    v_and_b32 v14, 3, v14
    v_lshl_add_u32 v15, v13, 3, v14
    s_mov_b32 s7, 512
    v_mul_lo_u32 v15, v15, s7
    v_lshrrev_b32 v16, 4, v0
    v_and_b32 v16, 1, v16
    v_lshl_add_u32 v15, v16, 5, v15
    v_and_b32 v16, 3, v0
    v_lshl_add_u32 v15, v16, 3, v15
    v_add_u32 v15, 32768, v15
    s_mul_i32 s7, s6, 4
    s_add_u32 s26, s7, 0
    s_and_b32 s27, s26, 3
    v_xor_b32 v16, s27, v14
    s_andn2_b32 s26, s26, 3
    v_add_u32 v16, s26, v16
    v_lshl_add_u32 v8, v16, 6, v15
    s_add_u32 s26, s7, 1
    s_and_b32 s27, s26, 3
    v_xor_b32 v16, s27, v14
    s_andn2_b32 s26, s26, 3
    v_add_u32 v16, s26, v16
    v_lshl_add_u32 v9, v16, 6, v15
    s_add_u32 s26, s7, 2
    s_and_b32 s27, s26, 3
    v_xor_b32 v16, s27, v14
    s_andn2_b32 s26, s26, 3
    v_add_u32 v16, s26, v16
    v_lshl_add_u32 v10, v16, 6, v15
    s_add_u32 s26, s7, 3
    s_and_b32 s27, s26, 3
    v_xor_b32 v16, s27, v14
    s_andn2_b32 s26, s26, 3
    v_add_u32 v16, s26, v16
    v_lshl_add_u32 v11, v16, 6, v15
    v_mov_b32 v128, 0
    v_mov_b32 v129, 0
    v_mov_b32 v130, 0
    v_mov_b32 v131, 0
    v_mov_b32 v132, 0
    v_mov_b32 v133, 0
    v_mov_b32 v134, 0
    v_mov_b32 v135, 0
    v_mov_b32 v136, 0
    v_mov_b32 v137, 0
    v_mov_b32 v138, 0
    v_mov_b32 v139, 0
    v_mov_b32 v140, 0
    v_mov_b32 v141, 0
    v_mov_b32 v142, 0
    v_mov_b32 v143, 0
    v_mov_b32 v144, 0
    v_mov_b32 v145, 0
    v_mov_b32 v146, 0
    v_mov_b32 v147, 0
    v_mov_b32 v148, 0
    v_mov_b32 v149, 0
    v_mov_b32 v150, 0
    v_mov_b32 v151, 0
    v_mov_b32 v152, 0
    v_mov_b32 v153, 0
    v_mov_b32 v154, 0
    v_mov_b32 v155, 0
    v_mov_b32 v156, 0
    v_mov_b32 v157, 0
    v_mov_b32 v158, 0
    v_mov_b32 v159, 0
    v_mov_b32 v160, 0
    v_mov_b32 v161, 0
    v_mov_b32 v162, 0
    v_mov_b32 v163, 0
    v_mov_b32 v164, 0
    v_mov_b32 v165, 0
    v_mov_b32 v166, 0
    v_mov_b32 v167, 0
    v_mov_b32 v168, 0
    v_mov_b32 v169, 0
    v_mov_b32 v170, 0
    v_mov_b32 v171, 0
    v_mov_b32 v172, 0
    v_mov_b32 v173, 0
    v_mov_b32 v174, 0
    v_mov_b32 v175, 0
    v_mov_b32 v176, 0
    v_mov_b32 v177, 0
    v_mov_b32 v178, 0
    v_mov_b32 v179, 0
    v_mov_b32 v180, 0
    v_mov_b32 v181, 0
    v_mov_b32 v182, 0
    v_mov_b32 v183, 0
    v_mov_b32 v184, 0
    v_mov_b32 v185, 0
    v_mov_b32 v186, 0
    v_mov_b32 v187, 0
    v_mov_b32 v188, 0
    v_mov_b32 v189, 0
    v_mov_b32 v190, 0
    v_mov_b32 v191, 0
    v_mov_b32 v192, 0
    v_mov_b32 v193, 0
    v_mov_b32 v194, 0
    v_mov_b32 v195, 0
    v_mov_b32 v196, 0
    v_mov_b32 v197, 0
    v_mov_b32 v198, 0
    v_mov_b32 v199, 0
    v_mov_b32 v200, 0
    v_mov_b32 v201, 0
    v_mov_b32 v202, 0
    v_mov_b32 v203, 0
    v_mov_b32 v204, 0
    v_mov_b32 v205, 0
    v_mov_b32 v206, 0
    v_mov_b32 v207, 0
    v_mov_b32 v208, 0
    v_mov_b32 v209, 0
    v_mov_b32 v210, 0
    v_mov_b32 v211, 0
    v_mov_b32 v212, 0
    v_mov_b32 v213, 0
    v_mov_b32 v214, 0
    v_mov_b32 v215, 0
    v_mov_b32 v216, 0
    v_mov_b32 v217, 0
    v_mov_b32 v218, 0
    v_mov_b32 v219, 0
    v_mov_b32 v220, 0
    v_mov_b32 v221, 0
    v_mov_b32 v222, 0
    v_mov_b32 v223, 0
    v_mov_b32 v224, 0
    v_mov_b32 v225, 0
    v_mov_b32 v226, 0
    v_mov_b32 v227, 0
    v_mov_b32 v228, 0
    v_mov_b32 v229, 0
    v_mov_b32 v230, 0
    v_mov_b32 v231, 0
    v_mov_b32 v232, 0
    v_mov_b32 v233, 0
    v_mov_b32 v234, 0
    v_mov_b32 v235, 0
    v_mov_b32 v236, 0
    v_mov_b32 v237, 0
    v_mov_b32 v238, 0
    v_mov_b32 v239, 0
    v_mov_b32 v240, 0
    v_mov_b32 v241, 0
    v_mov_b32 v242, 0
    v_mov_b32 v243, 0
    v_mov_b32 v244, 0
    v_mov_b32 v245, 0
    v_mov_b32 v246, 0
    v_mov_b32 v247, 0
    v_mov_b32 v248, 0
    v_mov_b32 v249, 0
    v_mov_b32 v250, 0
    v_mov_b32 v251, 0
    v_mov_b32 v252, 0
    v_mov_b32 v253, 0
    v_mov_b32 v254, 0
    v_mov_b32 v255, 0
    s_mov_b32 s40, s36
    s_mov_b32 s41, s37
    s_lshl_b32 s42, s20, 6
    s_mul_i32 s43, s20, 16
    s_lshl_b32 s44, s4, 10
    s_mov_b32 s45, 0
    v_mov_b32 v20, v4
    v_mov_b32 v21, v5
    v_mov_b32 v22, v6
    v_mov_b32 v23, v7
    v_mov_b32 v24, v8
    v_mov_b32 v25, v9
    v_mov_b32 v26, v10
    v_mov_b32 v27, v11
    s_mov_b32 s48, 0
    s_add_u32 s46, s40, 0
    s_add_u32 m0, s44, 0
    s_nop 0
    buffer_load_dwordx4 v2, s[8:11], s46 offen lds
    s_add_u32 s46, s40, 131072
    s_add_u32 m0, s44, 8192
    s_nop 0
    buffer_load_dwordx4 v2, s[8:11], s46 offen lds
    s_add_u32 s46, s40, 262144
    s_add_u32 m0, s44, 16384
    s_nop 0
    buffer_load_dwordx4 v2, s[8:11], s46 offen lds
    s_add_u32 s46, s40, 393216
    s_add_u32 m0, s44, 24576
    s_nop 0
    buffer_load_dwordx4 v2, s[8:11], s46 offen lds
    s_add_u32 m0, s44, 32768
    s_mov_b32 s49, s41
    buffer_load_dwordx4 v3, s[12:15], s49 offen lds
    s_add_u32 m0, s44, 40960
    s_add_u32 s49, s49, s43
    buffer_load_dwordx4 v3, s[12:15], s49 offen lds
    s_add_u32 m0, s44, 49152
    s_add_u32 s49, s49, s43
    buffer_load_dwordx4 v3, s[12:15], s49 offen lds
    s_add_u32 m0, s44, 57344
    s_add_u32 s49, s49, s43
    buffer_load_dwordx4 v3, s[12:15], s49 offen lds
    s_add_u32 s40, s40, 128
    s_add_u32 s41, s41, s42
    s_add_u32 s44, s44, 65536
    s_cmp_ge_u32 s44, 131072
    s_cselect_b32 s46, 131072, 0
    s_sub_u32 s44, s44, s46
gemm1_kernel_loop4:
    s_waitcnt vmcnt(0)
    s_barrier
    s_add_u32 s45, s45, 1
    ds_read_b64_tr_b16 v[28:29], v8 offset:0
    ds_read_b64_tr_b16 v[30:31], v8 offset:2048
    ds_read_b64_tr_b16 v[32:33], v9 offset:0
    ds_read_b64_tr_b16 v[34:35], v9 offset:2048
    ds_read_b64_tr_b16 v[36:37], v10 offset:0
    ds_read_b64_tr_b16 v[38:39], v10 offset:2048
    ds_read_b64_tr_b16 v[40:41], v11 offset:0
    ds_read_b64_tr_b16 v[42:43], v11 offset:2048
    ds_read_b128 v[44:47], v4 offset:0
    ds_read_b128 v[48:51], v4 offset:4096
    ds_read_b64_tr_b16 v[52:53], v8 offset:8192
    ds_read_b64_tr_b16 v[54:55], v8 offset:10240
    ds_read_b64_tr_b16 v[56:57], v9 offset:8192
    ds_read_b64_tr_b16 v[58:59], v9 offset:10240
    ds_read_b64_tr_b16 v[60:61], v10 offset:8192
    ds_read_b64_tr_b16 v[62:63], v10 offset:10240
    ds_read_b64_tr_b16 v[64:65], v11 offset:8192
    ds_read_b64_tr_b16 v[66:67], v11 offset:10240
    ds_read_b128 v[68:71], v5 offset:0
    ds_read_b128 v[72:75], v5 offset:4096
    s_waitcnt lgkmcnt(10)
    v_mfma_f32_32x32x16_bf16 v[128:143], v[28:31], v[44:47], v[128:143]
    s_add_u32 s46, s40, 0
    s_add_u32 m0, s44, 0
    s_nop 0
    buffer_load_dwordx4 v2, s[8:11], s46 offen lds
    v_mfma_f32_32x32x16_bf16 v[144:159], v[32:35], v[44:47], v[144:159]
    s_add_u32 s46, s40, 131072
    s_add_u32 m0, s44, 8192
    s_nop 0
    buffer_load_dwordx4 v2, s[8:11], s46 offen lds
    v_mfma_f32_32x32x16_bf16 v[160:175], v[36:39], v[44:47], v[160:175]
    s_add_u32 s46, s40, 262144
    s_add_u32 m0, s44, 16384
    s_nop 0
    buffer_load_dwordx4 v2, s[8:11], s46 offen lds
    v_mfma_f32_32x32x16_bf16 v[176:191], v[40:43], v[44:47], v[176:191]
    s_add_u32 s46, s40, 393216
    s_add_u32 m0, s44, 24576
    s_nop 0
    buffer_load_dwordx4 v2, s[8:11], s46 offen lds
    v_mfma_f32_32x32x16_bf16 v[192:207], v[28:31], v[48:51], v[192:207]
    s_add_u32 m0, s44, 32768
    s_mov_b32 s49, s41
    buffer_load_dwordx4 v3, s[12:15], s49 offen lds
    v_mfma_f32_32x32x16_bf16 v[208:223], v[32:35], v[48:51], v[208:223]
    s_add_u32 m0, s44, 40960
    s_add_u32 s49, s49, s43
    buffer_load_dwordx4 v3, s[12:15], s49 offen lds
    v_mfma_f32_32x32x16_bf16 v[224:239], v[36:39], v[48:51], v[224:239]
    s_add_u32 m0, s44, 49152
    s_add_u32 s49, s49, s43
    buffer_load_dwordx4 v3, s[12:15], s49 offen lds
    v_mfma_f32_32x32x16_bf16 v[240:255], v[40:43], v[48:51], v[240:255]
    s_add_u32 m0, s44, 57344
    s_add_u32 s49, s49, s43
    buffer_load_dwordx4 v3, s[12:15], s49 offen lds
    s_add_u32 s40, s40, 128
    s_add_u32 s41, s41, s42
    s_add_u32 s44, s44, 65536
    s_cmp_ge_u32 s44, 131072
    s_cselect_b32 s46, 131072, 0
    s_sub_u32 s44, s44, s46
    ds_read_b64_tr_b16 v[28:29], v8 offset:16384
    ds_read_b64_tr_b16 v[30:31], v8 offset:18432
    ds_read_b64_tr_b16 v[32:33], v9 offset:16384
    ds_read_b64_tr_b16 v[34:35], v9 offset:18432
    ds_read_b64_tr_b16 v[36:37], v10 offset:16384
    ds_read_b64_tr_b16 v[38:39], v10 offset:18432
    ds_read_b64_tr_b16 v[40:41], v11 offset:16384
    ds_read_b64_tr_b16 v[42:43], v11 offset:18432
    ds_read_b128 v[44:47], v6 offset:0
    ds_read_b128 v[48:51], v6 offset:4096
    s_waitcnt lgkmcnt(10)
    v_mfma_f32_32x32x16_bf16 v[128:143], v[52:55], v[68:71], v[128:143]
    v_mfma_f32_32x32x16_bf16 v[144:159], v[56:59], v[68:71], v[144:159]
    v_mfma_f32_32x32x16_bf16 v[160:175], v[60:63], v[68:71], v[160:175]
    v_mfma_f32_32x32x16_bf16 v[176:191], v[64:67], v[68:71], v[176:191]
    v_mfma_f32_32x32x16_bf16 v[192:207], v[52:55], v[72:75], v[192:207]
    v_mfma_f32_32x32x16_bf16 v[208:223], v[56:59], v[72:75], v[208:223]
    v_mfma_f32_32x32x16_bf16 v[224:239], v[60:63], v[72:75], v[224:239]
    v_mfma_f32_32x32x16_bf16 v[240:255], v[64:67], v[72:75], v[240:255]
    ds_read_b64_tr_b16 v[52:53], v8 offset:24576
    ds_read_b64_tr_b16 v[54:55], v8 offset:26624
    ds_read_b64_tr_b16 v[56:57], v9 offset:24576
    ds_read_b64_tr_b16 v[58:59], v9 offset:26624
    ds_read_b64_tr_b16 v[60:61], v10 offset:24576
    ds_read_b64_tr_b16 v[62:63], v10 offset:26624
    ds_read_b64_tr_b16 v[64:65], v11 offset:24576
    ds_read_b64_tr_b16 v[66:67], v11 offset:26624
    ds_read_b128 v[68:71], v7 offset:0
    ds_read_b128 v[72:75], v7 offset:4096
    s_waitcnt lgkmcnt(10)
    v_mfma_f32_32x32x16_bf16 v[128:143], v[28:31], v[44:47], v[128:143]
    v_mfma_f32_32x32x16_bf16 v[144:159], v[32:35], v[44:47], v[144:159]
    v_mfma_f32_32x32x16_bf16 v[160:175], v[36:39], v[44:47], v[160:175]
    v_mfma_f32_32x32x16_bf16 v[176:191], v[40:43], v[44:47], v[176:191]
    v_mfma_f32_32x32x16_bf16 v[192:207], v[28:31], v[48:51], v[192:207]
    v_mfma_f32_32x32x16_bf16 v[208:223], v[32:35], v[48:51], v[208:223]
    v_mfma_f32_32x32x16_bf16 v[224:239], v[36:39], v[48:51], v[224:239]
    v_mfma_f32_32x32x16_bf16 v[240:255], v[40:43], v[48:51], v[240:255]
    s_waitcnt lgkmcnt(0)
    v_mfma_f32_32x32x16_bf16 v[128:143], v[52:55], v[68:71], v[128:143]
    v_mfma_f32_32x32x16_bf16 v[144:159], v[56:59], v[68:71], v[144:159]
    v_mfma_f32_32x32x16_bf16 v[160:175], v[60:63], v[68:71], v[160:175]
    v_mfma_f32_32x32x16_bf16 v[176:191], v[64:67], v[68:71], v[176:191]
    v_mfma_f32_32x32x16_bf16 v[192:207], v[52:55], v[72:75], v[192:207]
    v_mfma_f32_32x32x16_bf16 v[208:223], v[56:59], v[72:75], v[208:223]
    v_mfma_f32_32x32x16_bf16 v[224:239], v[60:63], v[72:75], v[224:239]
    v_mfma_f32_32x32x16_bf16 v[240:255], v[64:67], v[72:75], v[240:255]
    s_add_u32 s48, s48, 65536
    s_cmp_ge_u32 s48, 131072
    s_cselect_b32 s48, 0, s48
    v_add_u32 v4, s48, v20
    v_add_u32 v5, s48, v21
    v_add_u32 v6, s48, v22
    v_add_u32 v7, s48, v23
    v_add_u32 v8, s48, v24
    v_add_u32 v9, s48, v25
    v_add_u32 v10, s48, v26
    v_add_u32 v11, s48, v27
    s_cmp_lt_u32 s45, 16
    s_cbranch_scc1 gemm1_kernel_loop4
    s_waitcnt vmcnt(0)
    s_mul_i32 s7, s5, 64
    s_add_u32 s7, s7, s23
    v_add_u32 v14, s7, v12
    v_mul_lo_u32 v15, v14, s21
    s_mul_i32 s7, s6, 128
    s_add_u32 s7, s7, s25
    s_lshl_b32 s7, s7, 1
    v_add_u32 v15, s7, v15
    v_lshl_add_u32 v16, v13, 4, v15
    v_lshl_add_u32 v17, v13, 3, v15
    v_lshlrev_b32 v18, 1, v17
    s_lshl_b32 s47, s21, 5
    s_nop 7
    s_nop 7
    v_max_f32 v128, s22, v128
    v_mul_f32 v128, s38, v128
    v_max_f32 v129, s22, v129
    v_mul_f32 v129, s38, v129
    v_max_f32 v130, s22, v130
    v_mul_f32 v130, s38, v130
    v_max_f32 v131, s22, v131
    v_mul_f32 v131, s38, v131
    v_max_f32 v132, s22, v132
    v_mul_f32 v132, s38, v132
    v_max_f32 v133, s22, v133
    v_mul_f32 v133, s38, v133
    v_max_f32 v134, s22, v134
    v_mul_f32 v134, s38, v134
    v_max_f32 v135, s22, v135
    v_mul_f32 v135, s38, v135
    v_max_f32 v136, s22, v136
    v_mul_f32 v136, s38, v136
    v_max_f32 v137, s22, v137
    v_mul_f32 v137, s38, v137
    v_max_f32 v138, s22, v138
    v_mul_f32 v138, s38, v138
    v_max_f32 v139, s22, v139
    v_mul_f32 v139, s38, v139
    v_max_f32 v140, s22, v140
    v_mul_f32 v140, s38, v140
    v_max_f32 v141, s22, v141
    v_mul_f32 v141, s38, v141
    v_max_f32 v142, s22, v142
    v_mul_f32 v142, s38, v142
    v_max_f32 v143, s22, v143
    v_mul_f32 v143, s38, v143
    v_cvt_pk_bf16_f32 v128, v128, v129
    v_cvt_pk_bf16_f32 v129, v130, v131
    v_cvt_pk_bf16_f32 v130, v132, v133
    v_cvt_pk_bf16_f32 v131, v134, v135
    v_cvt_pk_bf16_f32 v132, v136, v137
    v_cvt_pk_bf16_f32 v133, v138, v139
    v_cvt_pk_bf16_f32 v134, v140, v141
    v_cvt_pk_bf16_f32 v135, v142, v143
    s_nop 1
    v_permlane32_swap_b32 v128, v130
    v_permlane32_swap_b32 v129, v131
    v_permlane32_swap_b32 v132, v134
    v_permlane32_swap_b32 v133, v135
    buffer_store_dwordx4 v[128:131], v16, s[16:19], 0 offen offset:0
    buffer_store_dwordx4 v[132:135], v16, s[16:19], 0 offen offset:32
    v_max_f32 v144, s22, v144
    v_mul_f32 v144, s38, v144
    v_max_f32 v145, s22, v145
    v_mul_f32 v145, s38, v145
    v_max_f32 v146, s22, v146
    v_mul_f32 v146, s38, v146
    v_max_f32 v147, s22, v147
    v_mul_f32 v147, s38, v147
    v_max_f32 v148, s22, v148
    v_mul_f32 v148, s38, v148
    v_max_f32 v149, s22, v149
    v_mul_f32 v149, s38, v149
    v_max_f32 v150, s22, v150
    v_mul_f32 v150, s38, v150
    v_max_f32 v151, s22, v151
    v_mul_f32 v151, s38, v151
    v_max_f32 v152, s22, v152
    v_mul_f32 v152, s38, v152
    v_max_f32 v153, s22, v153
    v_mul_f32 v153, s38, v153
    v_max_f32 v154, s22, v154
    v_mul_f32 v154, s38, v154
    v_max_f32 v155, s22, v155
    v_mul_f32 v155, s38, v155
    v_max_f32 v156, s22, v156
    v_mul_f32 v156, s38, v156
    v_max_f32 v157, s22, v157
    v_mul_f32 v157, s38, v157
    v_max_f32 v158, s22, v158
    v_mul_f32 v158, s38, v158
    v_max_f32 v159, s22, v159
    v_mul_f32 v159, s38, v159
    v_cvt_pk_bf16_f32 v144, v144, v145
    v_cvt_pk_bf16_f32 v145, v146, v147
    v_cvt_pk_bf16_f32 v146, v148, v149
    v_cvt_pk_bf16_f32 v147, v150, v151
    v_cvt_pk_bf16_f32 v148, v152, v153
    v_cvt_pk_bf16_f32 v149, v154, v155
    v_cvt_pk_bf16_f32 v150, v156, v157
    v_cvt_pk_bf16_f32 v151, v158, v159
    s_nop 1
    v_permlane32_swap_b32 v144, v146
    v_permlane32_swap_b32 v145, v147
    v_permlane32_swap_b32 v148, v150
    v_permlane32_swap_b32 v149, v151
    buffer_store_dwordx4 v[144:147], v16, s[16:19], 0 offen offset:64
    buffer_store_dwordx4 v[148:151], v16, s[16:19], 0 offen offset:96
    v_max_f32 v160, s22, v160
    v_mul_f32 v160, s38, v160
    v_max_f32 v161, s22, v161
    v_mul_f32 v161, s38, v161
    v_max_f32 v162, s22, v162
    v_mul_f32 v162, s38, v162
    v_max_f32 v163, s22, v163
    v_mul_f32 v163, s38, v163
    v_max_f32 v164, s22, v164
    v_mul_f32 v164, s38, v164
    v_max_f32 v165, s22, v165
    v_mul_f32 v165, s38, v165
    v_max_f32 v166, s22, v166
    v_mul_f32 v166, s38, v166
    v_max_f32 v167, s22, v167
    v_mul_f32 v167, s38, v167
    v_max_f32 v168, s22, v168
    v_mul_f32 v168, s38, v168
    v_max_f32 v169, s22, v169
    v_mul_f32 v169, s38, v169
    v_max_f32 v170, s22, v170
    v_mul_f32 v170, s38, v170
    v_max_f32 v171, s22, v171
    v_mul_f32 v171, s38, v171
    v_max_f32 v172, s22, v172
    v_mul_f32 v172, s38, v172
    v_max_f32 v173, s22, v173
    v_mul_f32 v173, s38, v173
    v_max_f32 v174, s22, v174
    v_mul_f32 v174, s38, v174
    v_max_f32 v175, s22, v175
    v_mul_f32 v175, s38, v175
    v_cvt_pk_bf16_f32 v160, v160, v161
    v_cvt_pk_bf16_f32 v161, v162, v163
    v_cvt_pk_bf16_f32 v162, v164, v165
    v_cvt_pk_bf16_f32 v163, v166, v167
    v_cvt_pk_bf16_f32 v164, v168, v169
    v_cvt_pk_bf16_f32 v165, v170, v171
    v_cvt_pk_bf16_f32 v166, v172, v173
    v_cvt_pk_bf16_f32 v167, v174, v175
    s_nop 1
    v_permlane32_swap_b32 v160, v162
    v_permlane32_swap_b32 v161, v163
    v_permlane32_swap_b32 v164, v166
    v_permlane32_swap_b32 v165, v167
    buffer_store_dwordx4 v[160:163], v16, s[16:19], 0 offen offset:128
    buffer_store_dwordx4 v[164:167], v16, s[16:19], 0 offen offset:160
    v_max_f32 v176, s22, v176
    v_mul_f32 v176, s38, v176
    v_max_f32 v177, s22, v177
    v_mul_f32 v177, s38, v177
    v_max_f32 v178, s22, v178
    v_mul_f32 v178, s38, v178
    v_max_f32 v179, s22, v179
    v_mul_f32 v179, s38, v179
    v_max_f32 v180, s22, v180
    v_mul_f32 v180, s38, v180
    v_max_f32 v181, s22, v181
    v_mul_f32 v181, s38, v181
    v_max_f32 v182, s22, v182
    v_mul_f32 v182, s38, v182
    v_max_f32 v183, s22, v183
    v_mul_f32 v183, s38, v183
    v_max_f32 v184, s22, v184
    v_mul_f32 v184, s38, v184
    v_max_f32 v185, s22, v185
    v_mul_f32 v185, s38, v185
    v_max_f32 v186, s22, v186
    v_mul_f32 v186, s38, v186
    v_max_f32 v187, s22, v187
    v_mul_f32 v187, s38, v187
    v_max_f32 v188, s22, v188
    v_mul_f32 v188, s38, v188
    v_max_f32 v189, s22, v189
    v_mul_f32 v189, s38, v189
    v_max_f32 v190, s22, v190
    v_mul_f32 v190, s38, v190
    v_max_f32 v191, s22, v191
    v_mul_f32 v191, s38, v191
    v_cvt_pk_bf16_f32 v176, v176, v177
    v_cvt_pk_bf16_f32 v177, v178, v179
    v_cvt_pk_bf16_f32 v178, v180, v181
    v_cvt_pk_bf16_f32 v179, v182, v183
    v_cvt_pk_bf16_f32 v180, v184, v185
    v_cvt_pk_bf16_f32 v181, v186, v187
    v_cvt_pk_bf16_f32 v182, v188, v189
    v_cvt_pk_bf16_f32 v183, v190, v191
    s_nop 1
    v_permlane32_swap_b32 v176, v178
    v_permlane32_swap_b32 v177, v179
    v_permlane32_swap_b32 v180, v182
    v_permlane32_swap_b32 v181, v183
    buffer_store_dwordx4 v[176:179], v16, s[16:19], 0 offen offset:192
    buffer_store_dwordx4 v[180:183], v16, s[16:19], 0 offen offset:224
    v_add_u32 v16, s47, v16
    v_add_u32 v17, s47, v17
    v_lshlrev_b32 v18, 1, v17
    v_max_f32 v192, s22, v192
    v_mul_f32 v192, s38, v192
    v_max_f32 v193, s22, v193
    v_mul_f32 v193, s38, v193
    v_max_f32 v194, s22, v194
    v_mul_f32 v194, s38, v194
    v_max_f32 v195, s22, v195
    v_mul_f32 v195, s38, v195
    v_max_f32 v196, s22, v196
    v_mul_f32 v196, s38, v196
    v_max_f32 v197, s22, v197
    v_mul_f32 v197, s38, v197
    v_max_f32 v198, s22, v198
    v_mul_f32 v198, s38, v198
    v_max_f32 v199, s22, v199
    v_mul_f32 v199, s38, v199
    v_max_f32 v200, s22, v200
    v_mul_f32 v200, s38, v200
    v_max_f32 v201, s22, v201
    v_mul_f32 v201, s38, v201
    v_max_f32 v202, s22, v202
    v_mul_f32 v202, s38, v202
    v_max_f32 v203, s22, v203
    v_mul_f32 v203, s38, v203
    v_max_f32 v204, s22, v204
    v_mul_f32 v204, s38, v204
    v_max_f32 v205, s22, v205
    v_mul_f32 v205, s38, v205
    v_max_f32 v206, s22, v206
    v_mul_f32 v206, s38, v206
    v_max_f32 v207, s22, v207
    v_mul_f32 v207, s38, v207
    v_cvt_pk_bf16_f32 v192, v192, v193
    v_cvt_pk_bf16_f32 v193, v194, v195
    v_cvt_pk_bf16_f32 v194, v196, v197
    v_cvt_pk_bf16_f32 v195, v198, v199
    v_cvt_pk_bf16_f32 v196, v200, v201
    v_cvt_pk_bf16_f32 v197, v202, v203
    v_cvt_pk_bf16_f32 v198, v204, v205
    v_cvt_pk_bf16_f32 v199, v206, v207
    s_nop 1
    v_permlane32_swap_b32 v192, v194
    v_permlane32_swap_b32 v193, v195
    v_permlane32_swap_b32 v196, v198
    v_permlane32_swap_b32 v197, v199
    buffer_store_dwordx4 v[192:195], v16, s[16:19], 0 offen offset:0
    buffer_store_dwordx4 v[196:199], v16, s[16:19], 0 offen offset:32
    v_max_f32 v208, s22, v208
    v_mul_f32 v208, s38, v208
    v_max_f32 v209, s22, v209
    v_mul_f32 v209, s38, v209
    v_max_f32 v210, s22, v210
    v_mul_f32 v210, s38, v210
    v_max_f32 v211, s22, v211
    v_mul_f32 v211, s38, v211
    v_max_f32 v212, s22, v212
    v_mul_f32 v212, s38, v212
    v_max_f32 v213, s22, v213
    v_mul_f32 v213, s38, v213
    v_max_f32 v214, s22, v214
    v_mul_f32 v214, s38, v214
    v_max_f32 v215, s22, v215
    v_mul_f32 v215, s38, v215
    v_max_f32 v216, s22, v216
    v_mul_f32 v216, s38, v216
    v_max_f32 v217, s22, v217
    v_mul_f32 v217, s38, v217
    v_max_f32 v218, s22, v218
    v_mul_f32 v218, s38, v218
    v_max_f32 v219, s22, v219
    v_mul_f32 v219, s38, v219
    v_max_f32 v220, s22, v220
    v_mul_f32 v220, s38, v220
    v_max_f32 v221, s22, v221
    v_mul_f32 v221, s38, v221
    v_max_f32 v222, s22, v222
    v_mul_f32 v222, s38, v222
    v_max_f32 v223, s22, v223
    v_mul_f32 v223, s38, v223
    v_cvt_pk_bf16_f32 v208, v208, v209
    v_cvt_pk_bf16_f32 v209, v210, v211
    v_cvt_pk_bf16_f32 v210, v212, v213
    v_cvt_pk_bf16_f32 v211, v214, v215
    v_cvt_pk_bf16_f32 v212, v216, v217
    v_cvt_pk_bf16_f32 v213, v218, v219
    v_cvt_pk_bf16_f32 v214, v220, v221
    v_cvt_pk_bf16_f32 v215, v222, v223
    s_nop 1
    v_permlane32_swap_b32 v208, v210
    v_permlane32_swap_b32 v209, v211
    v_permlane32_swap_b32 v212, v214
    v_permlane32_swap_b32 v213, v215
    buffer_store_dwordx4 v[208:211], v16, s[16:19], 0 offen offset:64
    buffer_store_dwordx4 v[212:215], v16, s[16:19], 0 offen offset:96
    v_max_f32 v224, s22, v224
    v_mul_f32 v224, s38, v224
    v_max_f32 v225, s22, v225
    v_mul_f32 v225, s38, v225
    v_max_f32 v226, s22, v226
    v_mul_f32 v226, s38, v226
    v_max_f32 v227, s22, v227
    v_mul_f32 v227, s38, v227
    v_max_f32 v228, s22, v228
    v_mul_f32 v228, s38, v228
    v_max_f32 v229, s22, v229
    v_mul_f32 v229, s38, v229
    v_max_f32 v230, s22, v230
    v_mul_f32 v230, s38, v230
    v_max_f32 v231, s22, v231
    v_mul_f32 v231, s38, v231
    v_max_f32 v232, s22, v232
    v_mul_f32 v232, s38, v232
    v_max_f32 v233, s22, v233
    v_mul_f32 v233, s38, v233
    v_max_f32 v234, s22, v234
    v_mul_f32 v234, s38, v234
    v_max_f32 v235, s22, v235
    v_mul_f32 v235, s38, v235
    v_max_f32 v236, s22, v236
    v_mul_f32 v236, s38, v236
    v_max_f32 v237, s22, v237
    v_mul_f32 v237, s38, v237
    v_max_f32 v238, s22, v238
    v_mul_f32 v238, s38, v238
    v_max_f32 v239, s22, v239
    v_mul_f32 v239, s38, v239
    v_cvt_pk_bf16_f32 v224, v224, v225
    v_cvt_pk_bf16_f32 v225, v226, v227
    v_cvt_pk_bf16_f32 v226, v228, v229
    v_cvt_pk_bf16_f32 v227, v230, v231
    v_cvt_pk_bf16_f32 v228, v232, v233
    v_cvt_pk_bf16_f32 v229, v234, v235
    v_cvt_pk_bf16_f32 v230, v236, v237
    v_cvt_pk_bf16_f32 v231, v238, v239
    s_nop 1
    v_permlane32_swap_b32 v224, v226
    v_permlane32_swap_b32 v225, v227
    v_permlane32_swap_b32 v228, v230
    v_permlane32_swap_b32 v229, v231
    buffer_store_dwordx4 v[224:227], v16, s[16:19], 0 offen offset:128
    buffer_store_dwordx4 v[228:231], v16, s[16:19], 0 offen offset:160
    v_max_f32 v240, s22, v240
    v_mul_f32 v240, s38, v240
    v_max_f32 v241, s22, v241
    v_mul_f32 v241, s38, v241
    v_max_f32 v242, s22, v242
    v_mul_f32 v242, s38, v242
    v_max_f32 v243, s22, v243
    v_mul_f32 v243, s38, v243
    v_max_f32 v244, s22, v244
    v_mul_f32 v244, s38, v244
    v_max_f32 v245, s22, v245
    v_mul_f32 v245, s38, v245
    v_max_f32 v246, s22, v246
    v_mul_f32 v246, s38, v246
    v_max_f32 v247, s22, v247
    v_mul_f32 v247, s38, v247
    v_max_f32 v248, s22, v248
    v_mul_f32 v248, s38, v248
    v_max_f32 v249, s22, v249
    v_mul_f32 v249, s38, v249
    v_max_f32 v250, s22, v250
    v_mul_f32 v250, s38, v250
    v_max_f32 v251, s22, v251
    v_mul_f32 v251, s38, v251
    v_max_f32 v252, s22, v252
    v_mul_f32 v252, s38, v252
    v_max_f32 v253, s22, v253
    v_mul_f32 v253, s38, v253
    v_max_f32 v254, s22, v254
    v_mul_f32 v254, s38, v254
    v_max_f32 v255, s22, v255
    v_mul_f32 v255, s38, v255
    v_cvt_pk_bf16_f32 v240, v240, v241
    v_cvt_pk_bf16_f32 v241, v242, v243
    v_cvt_pk_bf16_f32 v242, v244, v245
    v_cvt_pk_bf16_f32 v243, v246, v247
    v_cvt_pk_bf16_f32 v244, v248, v249
    v_cvt_pk_bf16_f32 v245, v250, v251
    v_cvt_pk_bf16_f32 v246, v252, v253
    v_cvt_pk_bf16_f32 v247, v254, v255
    s_nop 1
    v_permlane32_swap_b32 v240, v242
    v_permlane32_swap_b32 v241, v243
    v_permlane32_swap_b32 v244, v246
    v_permlane32_swap_b32 v245, v247
    buffer_store_dwordx4 v[240:243], v16, s[16:19], 0 offen offset:192
    buffer_store_dwordx4 v[244:247], v16, s[16:19], 0 offen offset:224
gemm1_kernel_end:
    s_endpgm
.section .rodata,"a"
.p2align 6
.amdhsa_kernel gemm1_kernel
  .amdhsa_next_free_vgpr 256
  .amdhsa_next_free_sgpr 100
  .amdhsa_accum_offset 256
  .amdhsa_group_segment_fixed_size 0
  .amdhsa_kernarg_size 72
  .amdhsa_user_sgpr_count 2
  .amdhsa_user_sgpr_kernarg_segment_ptr 1
  .amdhsa_system_sgpr_workgroup_id_x 1
.end_amdhsa_kernel
.text
.globl mid_kernel
.p2align 8
.type mid_kernel,@function
mid_kernel:
    s_load_dwordx16 s[64:79], s[0:1], 0
    s_load_dwordx2 s[80:81], s[0:1], 64
    s_cmp_ge_u32 s2, 768
    s_cbranch_scc1 mid_kernel_end
    s_waitcnt lgkmcnt(0)
    s_cmp_ge_u32 s2, 256
    s_cbranch_scc1 mid_kernel_attn
    v_lshrrev_b32 v1, 6, v0
    v_and_b32 v0, 63, v0
    s_nop 0
    v_readfirstlane_b32 s4, v1
    s_lshr_b32 s7, s2, 3
    s_and_b32 s23, s7, 7
    s_lshr_b32 s24, s2, 1
    s_and_b32 s24, s24, 1
    s_lshl_b32 s24, s24, 3
    s_add_u32 s23, s23, s24
    s_lshl_b32 s23, s23, 7
    s_lshr_b32 s24, s7, 3
    s_and_b32 s7, s2, 1
    s_lshl_b32 s7, s7, 2
    s_add_u32 s24, s24, s7
    s_lshl_b32 s24, s24, 7
    s_lshr_b32 s7, s2, 2
    s_and_b32 s7, s7, 1
    s_add_u32 s8, s80, 0x1000000
    s_addc_u32 s9, s81, 0
    s_and_b32 s9, s9, 0xffff
    s_mov_b32 s10, 0x1200000
    s_mov_b32 s11, 0x00020000
    s_mov_b32 s12, s74
    s_mov_b32 s13, s75
    s_and_b32 s13, s13, 0xffff
    s_mov_b32 s14, 0x700000
    s_mov_b32 s15, 0x00020000
    s_add_u32 s16, s80, 0x2400000
    s_addc_u32 s17, s81, 0
    s_and_b32 s17, s17, 0xffff
    s_mov_b32 s18, 0x1000000
    s_mov_b32 s19, 0x00020000
    s_mul_i32 s36, s7, 3584
    s_add_u32 s36, s36, 2048
    s_mul_i32 s37, s7, 3670016
    s_mov_b32 s20, 2048
    s_mov_b32 s21, 4096
    s_mul_i32 s25, s7, 2097152
    s_add_u32 s25, s25, s24
    s_lshr_b32 s5, s4, 1
    s_and_b32 s6, s4, 1
    v_lshrrev_b32 v3, 3, v0
    s_lshl_b32 s7, s4, 3
    s_add_u32 s7, s7, s23
    v_add_u32 v3, s7, v3
    s_mov_b32 s7, 9216
    v_mul_lo_u32 v2, v3, s7
    s_and_b32 s7, s4, 1
    s_lshl_b32 s7, s7, 2
    v_lshrrev_b32 v3, 4, v0
    v_add_u32 v3, s7, v3
    v_and_b32 v3, 7, v3
    v_and_b32 v4, 7, v0
    v_xor_b32 v3, v3, v4
    v_lshl_add_u32 v2, v3, 4, v2
    v_lshrrev_b32 v4, 4, v0
    s_mul_i32 s7, s4, 4
    v_add_u32 v4, s7, v4
    v_mul_lo_u32 v3, v4, s20
    v_and_b32 v4, 3, v4
    v_lshlrev_b32 v4, 2, v4
    v_and_b32 v5, 15, v0
    v_xor_b32 v4, v4, v5
    v_lshl_add_u32 v3, v4, 4, v3
    s_lshl_b32 s7, s24, 1
    v_add_u32 v3, s7, v3
    v_and_b32 v12, 31, v0
    v_lshrrev_b32 v13, 5, v0
    s_mul_i32 s7, s5, 8192
    v_lshlrev_b32 v14, 7, v12
    v_add_u32 v14, s7, v14
    v_lshrrev_b32 v15, 1, v0
    v_and_b32 v15, 7, v15
    v_add_u32 v16, 0, v13
    v_xor_b32 v16, v16, v15
    v_lshl_add_u32 v4, v16, 4, v14
    v_add_u32 v16, 2, v13
    v_xor_b32 v16, v16, v15
    v_lshl_add_u32 v5, v16, 4, v14
    v_add_u32 v16, 4, v13
    v_xor_b32 v16, v16, v15
    v_lshl_add_u32 v6, v16, 4, v14
    v_add_u32 v16, 6, v13
    v_xor_b32 v16, v16, v15
    v_lshl_add_u32 v7, v16, 4, v14
    v_lshrrev_b32 v14, 2, v0
    v_and_b32 v14, 3, v14
    v_lshl_add_u32 v15, v13, 3, v14
    s_mov_b32 s7, 256
    v_mul_lo_u32 v15, v15, s7
    v_lshrrev_b32 v16, 4, v0
    v_and_b32 v16, 1, v16
    v_lshl_add_u32 v15, v16, 5, v15
    v_and_b32 v16, 3, v0
    v_lshl_add_u32 v15, v16, 3, v15
    v_add_u32 v15, 16384, v15
    s_mul_i32 s7, s6, 2
    s_add_u32 s26, s7, 0
    s_and_b32 s27, s26, 3
    v_xor_b32 v16, s27, v14
    s_andn2_b32 s26, s26, 3
    v_add_u32 v16, s26, v16
    v_lshl_add_u32 v8, v16, 6, v15
    s_add_u32 s26, s7, 1
    s_and_b32 s27, s26, 3
    v_xor_b32 v16, s27, v14
    s_andn2_b32 s26, s26, 3
    v_add_u32 v16, s26, v16
    v_lshl_add_u32 v9, v16, 6, v15
    v_mov_b32 v80, 0
    v_mov_b32 v81, 0
    v_mov_b32 v82, 0
    v_mov_b32 v83, 0
    v_mov_b32 v84, 0
    v_mov_b32 v85, 0
    v_mov_b32 v86, 0
    v_mov_b32 v87, 0
    v_mov_b32 v88, 0
    v_mov_b32 v89, 0
    v_mov_b32 v90, 0
    v_mov_b32 v91, 0
    v_mov_b32 v92, 0
    v_mov_b32 v93, 0
    v_mov_b32 v94, 0
    v_mov_b32 v95, 0
    v_mov_b32 v96, 0
    v_mov_b32 v97, 0
    v_mov_b32 v98, 0
    v_mov_b32 v99, 0
    v_mov_b32 v100, 0
    v_mov_b32 v101, 0
    v_mov_b32 v102, 0
    v_mov_b32 v103, 0
    v_mov_b32 v104, 0
    v_mov_b32 v105, 0
    v_mov_b32 v106, 0
    v_mov_b32 v107, 0
    v_mov_b32 v108, 0
    v_mov_b32 v109, 0
    v_mov_b32 v110, 0
    v_mov_b32 v111, 0
    v_mov_b32 v112, 0
    v_mov_b32 v113, 0
    v_mov_b32 v114, 0
    v_mov_b32 v115, 0
    v_mov_b32 v116, 0
    v_mov_b32 v117, 0
    v_mov_b32 v118, 0
    v_mov_b32 v119, 0
    v_mov_b32 v120, 0
    v_mov_b32 v121, 0
    v_mov_b32 v122, 0
    v_mov_b32 v123, 0
    v_mov_b32 v124, 0
    v_mov_b32 v125, 0
    v_mov_b32 v126, 0
    v_mov_b32 v127, 0
    v_mov_b32 v128, 0
    v_mov_b32 v129, 0
    v_mov_b32 v130, 0
    v_mov_b32 v131, 0
    v_mov_b32 v132, 0
    v_mov_b32 v133, 0
    v_mov_b32 v134, 0
    v_mov_b32 v135, 0
    v_mov_b32 v136, 0
    v_mov_b32 v137, 0
    v_mov_b32 v138, 0
    v_mov_b32 v139, 0
    v_mov_b32 v140, 0
    v_mov_b32 v141, 0
    v_mov_b32 v142, 0
    v_mov_b32 v143, 0
    s_mov_b32 s40, s36
    s_mov_b32 s41, s37
    s_lshl_b32 s42, s20, 6
    s_mul_i32 s43, s20, 16
    s_lshl_b32 s44, s4, 10
    s_mov_b32 s45, 0
    v_mov_b32 v20, v4
    v_mov_b32 v21, v5
    v_mov_b32 v22, v6
    v_mov_b32 v23, v7
    v_mov_b32 v24, v8
    v_mov_b32 v25, v9
    s_mov_b32 s48, 0
    s_add_u32 s46, s40, 0
    s_add_u32 m0, s44, 0
    s_nop 0
    buffer_load_dwordx4 v2, s[8:11], s46 offen lds
    s_add_u32 s46, s40, 294912
    s_add_u32 m0, s44, 4096
    s_nop 0
    buffer_load_dwordx4 v2, s[8:11], s46 offen lds
    s_add_u32 s46, s40, 589824
    s_add_u32 m0, s44, 8192
    s_nop 0
    buffer_load_dwordx4 v2, s[8:11], s46 offen lds
    s_add_u32 s46, s40, 884736
    s_add_u32 m0, s44, 12288
    s_nop 0
    buffer_load_dwordx4 v2, s[8:11], s46 offen lds
    s_add_u32 m0, s44, 16384
    s_mov_b32 s49, s41
    buffer_load_dwordx4 v3, s[12:15], s49 offen lds
    s_add_u32 m0, s44, 20480
    s_add_u32 s49, s49, s43
    buffer_load_dwordx4 v3, s[12:15], s49 offen lds
    s_add_u32 m0, s44, 24576
    s_add_u32 s49, s49, s43
    buffer_load_dwordx4 v3, s[12:15], s49 offen lds
    s_add_u32 m0, s44, 28672
    s_add_u32 s49, s49, s43
    buffer_load_dwordx4 v3, s[12:15], s49 offen lds
    s_add_u32 s40, s40, 128
    s_add_u32 s41, s41, s42
    s_add_u32 s44, s44, 32768
    s_cmp_ge_u32 s44, 65536
    s_cselect_b32 s46, 65536, 0
    s_sub_u32 s44, s44, s46
mid_kernel_loop1:
    s_waitcnt vmcnt(0)
    s_barrier
    s_add_u32 s45, s45, 1
    ds_read_b64_tr_b16 v[28:29], v8 offset:0
    ds_read_b64_tr_b16 v[30:31], v8 offset:1024
    ds_read_b64_tr_b16 v[32:33], v9 offset:0
    ds_read_b64_tr_b16 v[34:35], v9 offset:1024
    ds_read_b128 v[36:39], v4 offset:0
    ds_read_b128 v[40:43], v4 offset:4096
    ds_read_b64_tr_b16 v[44:45], v8 offset:4096
    ds_read_b64_tr_b16 v[46:47], v8 offset:5120
    ds_read_b64_tr_b16 v[48:49], v9 offset:4096
    ds_read_b64_tr_b16 v[50:51], v9 offset:5120
    ds_read_b128 v[52:55], v5 offset:0
    ds_read_b128 v[56:59], v5 offset:4096
    s_waitcnt lgkmcnt(6)
    v_mfma_f32_32x32x16_bf16 v[80:95], v[28:31], v[36:39], v[80:95]
    s_add_u32 s46, s40, 0
    s_add_u32 m0, s44, 0
    s_nop 0
    buffer_load_dwordx4 v2, s[8:11], s46 offen lds
    v_mfma_f32_32x32x16_bf16 v[96:111], v[32:35], v[36:39], v[96:111]
    s_add_u32 s46, s40, 294912
    s_add_u32 m0, s44, 4096
    s_nop 0
    buffer_load_dwordx4 v2, s[8:11], s46 offen lds
    v_mfma_f32_32x32x16_bf16 v[112:127], v[28:31], v[40:43], v[112:127]
    s_add_u32 s46, s40, 589824
    s_add_u32 m0, s44, 8192
    s_nop 0
    buffer_load_dwordx4 v2, s[8:11], s46 offen lds
    v_mfma_f32_32x32x16_bf16 v[128:143], v[32:35], v[40:43], v[128:143]
    s_add_u32 s46, s40, 884736
    s_add_u32 m0, s44, 12288
    s_nop 0
    buffer_load_dwordx4 v2, s[8:11], s46 offen lds
    ds_read_b64_tr_b16 v[28:29], v8 offset:8192
    ds_read_b64_tr_b16 v[30:31], v8 offset:9216
    ds_read_b64_tr_b16 v[32:33], v9 offset:8192
    ds_read_b64_tr_b16 v[34:35], v9 offset:9216
    ds_read_b128 v[36:39], v6 offset:0
    ds_read_b128 v[40:43], v6 offset:4096
    s_waitcnt lgkmcnt(6)
    v_mfma_f32_32x32x16_bf16 v[80:95], v[44:47], v[52:55], v[80:95]
    s_add_u32 m0, s44, 16384
    s_mov_b32 s49, s41
    buffer_load_dwordx4 v3, s[12:15], s49 offen lds
    v_mfma_f32_32x32x16_bf16 v[96:111], v[48:51], v[52:55], v[96:111]
    s_add_u32 m0, s44, 20480
    s_add_u32 s49, s49, s43
    buffer_load_dwordx4 v3, s[12:15], s49 offen lds
    v_mfma_f32_32x32x16_bf16 v[112:127], v[44:47], v[56:59], v[112:127]
    s_add_u32 m0, s44, 24576
    s_add_u32 s49, s49, s43
    buffer_load_dwordx4 v3, s[12:15], s49 offen lds
    v_mfma_f32_32x32x16_bf16 v[128:143], v[48:51], v[56:59], v[128:143]
    s_add_u32 m0, s44, 28672
    s_add_u32 s49, s49, s43
    buffer_load_dwordx4 v3, s[12:15], s49 offen lds
    s_add_u32 s40, s40, 128
    s_add_u32 s41, s41, s42
    s_add_u32 s44, s44, 32768
    s_cmp_ge_u32 s44, 65536
    s_cselect_b32 s46, 65536, 0
    s_sub_u32 s44, s44, s46
    ds_read_b64_tr_b16 v[44:45], v8 offset:12288
    ds_read_b64_tr_b16 v[46:47], v8 offset:13312
    ds_read_b64_tr_b16 v[48:49], v9 offset:12288
    ds_read_b64_tr_b16 v[50:51], v9 offset:13312
    ds_read_b128 v[52:55], v7 offset:0
    ds_read_b128 v[56:59], v7 offset:4096
    s_waitcnt lgkmcnt(6)
    v_mfma_f32_32x32x16_bf16 v[80:95], v[28:31], v[36:39], v[80:95]
    v_mfma_f32_32x32x16_bf16 v[96:111], v[32:35], v[36:39], v[96:111]
    v_mfma_f32_32x32x16_bf16 v[112:127], v[28:31], v[40:43], v[112:127]
    v_mfma_f32_32x32x16_bf16 v[128:143], v[32:35], v[40:43], v[128:143]
    s_waitcnt lgkmcnt(0)
    v_mfma_f32_32x32x16_bf16 v[80:95], v[44:47], v[52:55], v[80:95]
    v_mfma_f32_32x32x16_bf16 v[96:111], v[48:51], v[52:55], v[96:111]
    v_mfma_f32_32x32x16_bf16 v[112:127], v[44:47], v[56:59], v[112:127]
    v_mfma_f32_32x32x16_bf16 v[128:143], v[48:51], v[56:59], v[128:143]
    s_add_u32 s48, s48, 32768
    s_cmp_ge_u32 s48, 65536
    s_cselect_b32 s48, 0, s48
    v_add_u32 v4, s48, v20
    v_add_u32 v5, s48, v21
    v_add_u32 v6, s48, v22
    v_add_u32 v7, s48, v23
    v_add_u32 v8, s48, v24
    v_add_u32 v9, s48, v25
    s_cmp_lt_u32 s45, 28
    s_cbranch_scc1 mid_kernel_loop1
    s_waitcnt vmcnt(0)
    s_mul_i32 s7, s5, 64
    s_add_u32 s7, s7, s23
    v_add_u32 v14, s7, v12
    v_mul_lo_u32 v15, v14, s21
    s_mul_i32 s7, s6, 64
    s_add_u32 s7, s7, s25
    s_lshl_b32 s7, s7, 2
    v_add_u32 v15, s7, v15
    v_lshl_add_u32 v16, v13, 4, v15
    v_lshl_add_u32 v17, v13, 3, v15
    v_lshlrev_b32 v18, 1, v17
    s_lshl_b32 s47, s21, 5
    s_nop 7
    s_nop 7
    buffer_store_dwordx4 v[80:83], v16, s[16:19], 0 offen offset:0
    buffer_store_dwordx4 v[84:87], v16, s[16:19], 0 offen offset:32
    buffer_store_dwordx4 v[88:91], v16, s[16:19], 0 offen offset:64
    buffer_store_dwordx4 v[92:95], v16, s[16:19], 0 offen offset:96
    buffer_store_dwordx4 v[96:99], v16, s[16:19], 0 offen offset:128
    buffer_store_dwordx4 v[100:103], v16, s[16:19], 0 offen offset:160
    buffer_store_dwordx4 v[104:107], v16, s[16:19], 0 offen offset:192
    buffer_store_dwordx4 v[108:111], v16, s[16:19], 0 offen offset:224
    v_add_u32 v16, s47, v16
    v_add_u32 v17, s47, v17
    v_lshlrev_b32 v18, 1, v17
    buffer_store_dwordx4 v[112:115], v16, s[16:19], 0 offen offset:0
    buffer_store_dwordx4 v[116:119], v16, s[16:19], 0 offen offset:32
    buffer_store_dwordx4 v[120:123], v16, s[16:19], 0 offen offset:64
    buffer_store_dwordx4 v[124:127], v16, s[16:19], 0 offen offset:96
    buffer_store_dwordx4 v[128:131], v16, s[16:19], 0 offen offset:128
    buffer_store_dwordx4 v[132:135], v16, s[16:19], 0 offen offset:160
    buffer_store_dwordx4 v[136:139], v16, s[16:19], 0 offen offset:192
    buffer_store_dwordx4 v[140:143], v16, s[16:19], 0 offen offset:224
    s_endpgm
mid_kernel_attn:
    s_sub_u32 s3, s2, 256
    s_setprio 3
    v_lshrrev_b32 v1, 6, v0
    v_and_b32 v0, 63, v0
    s_nop 0
    v_readfirstlane_b32 s4, v1
    s_and_b32 s5, s3, 31
    s_lshr_b32 s6, s3, 5
    s_add_u32 s8, s80, 0x400000
    s_addc_u32 s9, s81, 0
    s_and_b32 s9, s9, 0xffff
    s_mov_b32 s10, 0xc00000
    s_mov_b32 s11, 0x00020000
    s_add_u32 s16, s80, 0x1000000
    s_addc_u32 s17, s81, 0
    s_and_b32 s17, s17, 0xffff
    s_mov_b32 s18, 0x1200000
    s_mov_b32 s19, 0x00020000
    v_and_b32 v12, 31, v0
    v_lshrrev_b32 v13, 5, v0
    s_lshl_b32 s7, s6, 7
    s_lshl_b32 s20, s4, 5
    s_add_u32 s7, s7, s20
    v_add_u32 v14, s7, v12
    s_mov_b32 s21, 6144
    v_mul_lo_u32 v15, v14, s21
    s_lshl_b32 s22, s5, 6
    v_add_u32 v15, s22, v15
    v_lshl_add_u32 v15, v13, 4, v15
    buffer_load_dwordx4 v[24:27], v15, s[8:11], 0 offen
    buffer_load_dwordx4 v[28:31], v15, s[8:11], 0 offen offset:32
    v_lshrrev_b32 v4, 2, v0
    s_lshl_b32 s7, s4, 4
    v_add_u32 v4, s7, v4
    v_mul_lo_u32 v4, v4, s21
    v_add_u32 v4, s22, v4
    v_and_b32 v5, 3, v0
    v_lshrrev_b32 v6, 4, v0
    v_xor_b32 v6, v6, v5
    v_lshl_add_u32 v2, v6, 4, v4
    v_add_u32 v2, 2048, v2
    v_lshl_add_u32 v3, v5, 4, v4
    v_add_u32 v3, 4096, v3
    v_lshrrev_b32 v7, 2, v0
    v_and_b32 v7, 3, v7
    v_add_u32 v8, 0, v13
    v_xor_b32 v8, v8, v7
    v_lshlrev_b32 v8, 4, v8
    v_lshl_add_u32 v4, v12, 6, v8
    v_add_u32 v8, 2, v13
    v_xor_b32 v8, v8, v7
    v_lshlrev_b32 v8, 4, v8
    v_lshl_add_u32 v5, v12, 6, v8
    v_lshl_add_u32 v8, v13, 2, v7
    v_lshlrev_b32 v8, 6, v8
    v_lshrrev_b32 v9, 4, v0
    v_and_b32 v9, 1, v9
    v_lshl_add_u32 v8, v9, 5, v8
    v_and_b32 v9, 3, v0
    v_lshl_add_u32 v8, v9, 3, v8
    v_add_u32 v6, 16384, v8
    v_mov_b32 v20, 0x3f803f80
    v_mov_b32 v21, 0x3f803f80
    v_mov_b32 v22, 0x3f803f80
    v_mov_b32 v23, 0x3f803f80
    v_mov_b32 v160, 0
    v_mov_b32 v161, 0
    v_mov_b32 v162, 0
    v_mov_b32 v163, 0
    v_mov_b32 v164, 0
    v_mov_b32 v165, 0
    v_mov_b32 v166, 0
    v_mov_b32 v167, 0
    v_mov_b32 v168, 0
    v_mov_b32 v169, 0
    v_mov_b32 v170, 0
    v_mov_b32 v171, 0
    v_mov_b32 v172, 0
    v_mov_b32 v173, 0
    v_mov_b32 v174, 0
    v_mov_b32 v175, 0
    v_mov_b32 v176, 0
    v_mov_b32 v177, 0
    v_mov_b32 v178, 0
    v_mov_b32 v179, 0
    v_mov_b32 v180, 0
    v_mov_b32 v181, 0
    v_mov_b32 v182, 0
    v_mov_b32 v183, 0
    v_mov_b32 v184, 0
    v_mov_b32 v185, 0
    v_mov_b32 v186, 0
    v_mov_b32 v187, 0
    v_mov_b32 v188, 0
    v_mov_b32 v189, 0
    v_mov_b32 v190, 0
    v_mov_b32 v191, 0
    v_mov_b32 v10, 0
    s_mov_b32 s40, 0
    s_mov_b32 s41, 0
    s_lshl_b32 s44, s4, 10
    s_mov_b32 s45, 0
    s_mov_b32 s30, 0x3e8293ee
    s_mov_b64 s[34:35], 0
    s_mov_b32 s31, 0x41000000
    s_add_u32 m0, s44, 0
    s_nop 0
    buffer_load_dwordx4 v2, s[8:11], s40 offen lds
    s_add_u32 s40, s40, 393216
    s_add_u32 m0, s44, 4096
    s_nop 0
    buffer_load_dwordx4 v2, s[8:11], s40 offen lds
    s_add_u32 s40, s40, 393216
    s_add_u32 m0, s44, 8192
    s_nop 0
    buffer_load_dwordx4 v2, s[8:11], s40 offen lds
    s_add_u32 s40, s40, 393216
    s_add_u32 m0, s44, 16384
    s_nop 0
    buffer_load_dwordx4 v3, s[8:11], s41 offen lds
    s_add_u32 s41, s41, 393216
    s_add_u32 m0, s44, 12288
    s_nop 0
    buffer_load_dwordx4 v2, s[8:11], s40 offen lds
    s_add_u32 s40, s40, 393216
    s_add_u32 m0, s44, 20480
    s_nop 0
    buffer_load_dwordx4 v3, s[8:11], s41 offen lds
    s_add_u32 s41, s41, 393216
    s_waitcnt vmcnt(4)
    s_barrier
    ds_read_b128 v[32:35], v4 offset:0
    ds_read_b128 v[36:39], v5 offset:0
    ds_read_b128 v[40:43], v4 offset:2048
    ds_read_b128 v[44:47], v5 offset:2048
    s_waitcnt lgkmcnt(0)
    v_mfma_f32_32x32x16_bf16 v[64:79], v[32:35], v[24:27], 0
    v_mfma_f32_32x32x16_bf16 v[64:79], v[36:39], v[28:31], v[64:79]
    v_mfma_f32_32x32x16_bf16 v[80:95], v[40:43], v[24:27], 0
    v_mfma_f32_32x32x16_bf16 v[80:95], v[44:47], v[28:31], v[80:95]
    s_nop 7
    s_nop 3
    s_waitcnt vmcnt(4)
    s_barrier
    ds_read_b128 v[32:35], v4 offset:4096
    ds_read_b128 v[36:39], v5 offset:4096
    ds_read_b128 v[40:43], v4 offset:6144
    ds_read_b128 v[44:47], v5 offset:6144
    s_add_u32 m0, s44, 0
    s_nop 0
    buffer_load_dwordx4 v2, s[8:11], s40 offen lds
    s_add_u32 s40, s40, 393216
    s_add_u32 m0, s44, 24576
    s_nop 0
    buffer_load_dwordx4 v3, s[8:11], s41 offen lds
    s_add_u32 s41, s41, 393216
    v_max3_f32 v11, v64, v65, v66
    v_max3_f32 v9, v79, v80, v81
    v_max3_f32 v11, v11, v67, v68
    v_max3_f32 v9, v9, v82, v83
    v_max3_f32 v11, v11, v69, v70
    v_max3_f32 v9, v9, v84, v85
    v_max3_f32 v11, v11, v71, v72
    v_max3_f32 v9, v9, v86, v87
    v_max3_f32 v11, v11, v73, v74
    v_max3_f32 v9, v9, v88, v89
    v_max3_f32 v11, v11, v75, v76
    v_max3_f32 v9, v9, v90, v91
    v_max3_f32 v11, v11, v77, v78
    v_max3_f32 v9, v9, v92, v93
    v_max3_f32 v9, v9, v94, v95
    v_max_f32 v11, v11, v9
    v_mov_b32 v9, v11
    s_nop 1
    v_permlane32_swap_b32 v11, v9
    v_max_f32 v11, v11, v9
    v_sub_f32 v64, v64, v11
    v_sub_f32 v65, v65, v11
    v_sub_f32 v66, v66, v11
    v_sub_f32 v67, v67, v11
    v_sub_f32 v68, v68, v11
    v_sub_f32 v69, v69, v11
    v_sub_f32 v70, v70, v11
    v_sub_f32 v71, v71, v11
    v_sub_f32 v72, v72, v11
    v_sub_f32 v73, v73, v11
    v_sub_f32 v74, v74, v11
    v_sub_f32 v75, v75, v11
    v_sub_f32 v76, v76, v11
    v_sub_f32 v77, v77, v11
    v_sub_f32 v78, v78, v11
    v_sub_f32 v79, v79, v11
    v_sub_f32 v80, v80, v11
    v_sub_f32 v81, v81, v11
    v_sub_f32 v82, v82, v11
    v_sub_f32 v83, v83, v11
    v_sub_f32 v84, v84, v11
    v_sub_f32 v85, v85, v11
    v_sub_f32 v86, v86, v11
    v_sub_f32 v87, v87, v11
    v_sub_f32 v88, v88, v11
    v_sub_f32 v89, v89, v11
    v_sub_f32 v90, v90, v11
    v_sub_f32 v91, v91, v11
    v_sub_f32 v92, v92, v11
    v_sub_f32 v93, v93, v11
    v_sub_f32 v94, v94, v11
    v_sub_f32 v95, v95, v11
    v_add_f32 v10, v10, v11
    v_exp_f32 v17, -v11
    v_sub_f32 v192, 0, v10
    v_sub_f32 v193, 0, v10
    v_sub_f32 v194, 0, v10
    v_sub_f32 v195, 0, v10
    v_sub_f32 v196, 0, v10
    v_sub_f32 v197, 0, v10
    v_sub_f32 v198, 0, v10
    v_sub_f32 v199, 0, v10
    v_sub_f32 v200, 0, v10
    v_sub_f32 v201, 0, v10
    v_sub_f32 v202, 0, v10
    v_sub_f32 v203, 0, v10
    v_sub_f32 v204, 0, v10
    v_sub_f32 v205, 0, v10
    v_sub_f32 v206, 0, v10
    v_sub_f32 v207, 0, v10
mid_kernel_nochg2:
    v_exp_f32 v64, v64
    v_exp_f32 v65, v65
    s_waitcnt lgkmcnt(0)
    v_mfma_f32_32x32x16_bf16 v[96:111], v[32:35], v[24:27], v[192:207]
    v_exp_f32 v66, v66
    v_exp_f32 v67, v67
    v_exp_f32 v68, v68
    v_exp_f32 v69, v69
    v_exp_f32 v70, v70
    v_exp_f32 v71, v71
    v_exp_f32 v72, v72
    v_exp_f32 v73, v73
    v_exp_f32 v74, v74
    v_exp_f32 v75, v75
    v_mfma_f32_32x32x16_bf16 v[96:111], v[36:39], v[28:31], v[96:111]
    v_exp_f32 v76, v76
    v_exp_f32 v77, v77
    v_exp_f32 v78, v78
    v_exp_f32 v79, v79
    v_cvt_pk_bf16_f32 v128, v64, v65
    v_cvt_pk_bf16_f32 v129, v66, v67
    v_cvt_pk_bf16_f32 v130, v68, v69
    v_cvt_pk_bf16_f32 v131, v70, v71
    v_exp_f32 v80, v80
    v_exp_f32 v81, v81
    v_mfma_f32_32x32x16_bf16 v[112:127], v[40:43], v[24:27], v[192:207]
    v_exp_f32 v82, v82
    v_exp_f32 v83, v83
    v_exp_f32 v84, v84
    v_exp_f32 v85, v85
    v_exp_f32 v86, v86
    v_exp_f32 v87, v87
    v_cvt_pk_bf16_f32 v132, v72, v73
    v_cvt_pk_bf16_f32 v133, v74, v75
    v_cvt_pk_bf16_f32 v134, v76, v77
    v_cvt_pk_bf16_f32 v135, v78, v79
    v_mfma_f32_32x32x16_bf16 v[112:127], v[44:47], v[28:31], v[112:127]
    v_exp_f32 v88, v88
    v_exp_f32 v89, v89
    v_exp_f32 v90, v90
    v_exp_f32 v91, v91
    v_exp_f32 v92, v92
    v_exp_f32 v93, v93
    v_exp_f32 v94, v94
    v_exp_f32 v95, v95
    v_cvt_pk_bf16_f32 v136, v80, v81
    v_cvt_pk_bf16_f32 v137, v82, v83
    v_cvt_pk_bf16_f32 v138, v84, v85
    v_cvt_pk_bf16_f32 v139, v86, v87
    v_cvt_pk_bf16_f32 v140, v88, v89
    v_cvt_pk_bf16_f32 v141, v90, v91
    v_cvt_pk_bf16_f32 v142, v92, v93
    v_cvt_pk_bf16_f32 v143, v94, v95
mid_kernel_loop3:
    s_waitcnt vmcnt(4)
    s_barrier
    ds_read_b128 v[32:35], v4 offset:8192
    ds_read_b128 v[36:39], v5 offset:8192
    ds_read_b128 v[40:43], v4 offset:10240
    ds_read_b128 v[44:47], v5 offset:10240
    ds_read_b64_tr_b16 v[48:49], v6 offset:0
    ds_read_b64_tr_b16 v[50:51], v6 offset:512
    ds_read_b64_tr_b16 v[52:53], v6 offset:1024
    ds_read_b64_tr_b16 v[54:55], v6 offset:1536
    ds_read_b64_tr_b16 v[56:57], v6 offset:2048
    ds_read_b64_tr_b16 v[58:59], v6 offset:2560
    ds_read_b64_tr_b16 v[60:61], v6 offset:3072
    ds_read_b64_tr_b16 v[62:63], v6 offset:3584
    s_add_u32 m0, s44, 4096
    s_nop 0
    buffer_load_dwordx4 v2, s[8:11], s40 offen lds
    s_add_u32 s40, s40, 393216
    s_add_u32 m0, s44, 28672
    s_nop 0
    buffer_load_dwordx4 v3, s[8:11], s41 offen lds
    s_add_u32 s41, s41, 393216
    v_exp_f32 v96, v96
    v_exp_f32 v97, v97
    s_waitcnt lgkmcnt(8)
    v_mfma_f32_32x32x16_bf16 v[64:79], v[32:35], v[24:27], v[192:207]
    v_exp_f32 v98, v98
    v_exp_f32 v99, v99
    v_exp_f32 v100, v100
    v_mfma_f32_32x32x16_bf16 v[64:79], v[36:39], v[28:31], v[64:79]
    v_exp_f32 v101, v101
    v_exp_f32 v102, v102
    v_exp_f32 v103, v103
    v_mfma_f32_32x32x16_bf16 v[80:95], v[40:43], v[24:27], v[192:207]
    v_exp_f32 v104, v104
    v_exp_f32 v105, v105
    v_exp_f32 v106, v106
    v_mfma_f32_32x32x16_bf16 v[80:95], v[44:47], v[28:31], v[80:95]
    v_exp_f32 v107, v107
    v_exp_f32 v108, v108
    v_exp_f32 v109, v109
    s_waitcnt lgkmcnt(0)
    v_mfma_f32_32x32x16_bf16 v[160:175], v[48:51], v[128:131], v[160:175]
    v_exp_f32 v110, v110
    v_exp_f32 v111, v111
    v_cvt_pk_bf16_f32 v144, v96, v97
    v_mfma_f32_32x32x16_bf16 v[176:191], v[20:23], v[128:131], v[176:191]
    v_cvt_pk_bf16_f32 v145, v98, v99
    v_cvt_pk_bf16_f32 v146, v100, v101
    v_cvt_pk_bf16_f32 v147, v102, v103
    v_mfma_f32_32x32x16_bf16 v[160:175], v[52:55], v[132:135], v[160:175]
    v_exp_f32 v112, v112
    v_exp_f32 v113, v113
    v_exp_f32 v114, v114
    v_mfma_f32_32x32x16_bf16 v[176:191], v[20:23], v[132:135], v[176:191]
    v_exp_f32 v115, v115
    v_exp_f32 v116, v116
    v_exp_f32 v117, v117
    v_mfma_f32_32x32x16_bf16 v[160:175], v[56:59], v[136:139], v[160:175]
    v_exp_f32 v118, v118
    v_exp_f32 v119, v119
    v_cvt_pk_bf16_f32 v148, v104, v105
    v_mfma_f32_32x32x16_bf16 v[176:191], v[20:23], v[136:139], v[176:191]
    v_cvt_pk_bf16_f32 v149, v106, v107
    v_cvt_pk_bf16_f32 v150, v108, v109
    v_cvt_pk_bf16_f32 v151, v110, v111
    v_mfma_f32_32x32x16_bf16 v[160:175], v[60:63], v[140:143], v[160:175]
    v_exp_f32 v120, v120
    v_exp_f32 v121, v121
    v_exp_f32 v122, v122
    v_mfma_f32_32x32x16_bf16 v[176:191], v[20:23], v[140:143], v[176:191]
    v_exp_f32 v123, v123
    v_exp_f32 v124, v124
    v_exp_f32 v125, v125
    v_exp_f32 v126, v126
    v_exp_f32 v127, v127
    v_cvt_pk_bf16_f32 v152, v112, v113
    v_cvt_pk_bf16_f32 v153, v114, v115
    v_cvt_pk_bf16_f32 v154, v116, v117
    v_cvt_pk_bf16_f32 v155, v118, v119
    v_cvt_pk_bf16_f32 v156, v120, v121
    v_cvt_pk_bf16_f32 v157, v122, v123
    v_cvt_pk_bf16_f32 v158, v124, v125
    v_cvt_pk_bf16_f32 v159, v126, v127
    s_waitcnt vmcnt(4)
    s_barrier
    ds_read_b128 v[32:35], v4 offset:12288
    ds_read_b128 v[36:39], v5 offset:12288
    ds_read_b128 v[40:43], v4 offset:14336
    ds_read_b128 v[44:47], v5 offset:14336
    ds_read_b64_tr_b16 v[48:49], v6 offset:4096
    ds_read_b64_tr_b16 v[50:51], v6 offset:4608
    ds_read_b64_tr_b16 v[52:53], v6 offset:5120
    ds_read_b64_tr_b16 v[54:55], v6 offset:5632
    ds_read_b64_tr_b16 v[56:57], v6 offset:6144
    ds_read_b64_tr_b16 v[58:59], v6 offset:6656
    ds_read_b64_tr_b16 v[60:61], v6 offset:7168
    ds_read_b64_tr_b16 v[62:63], v6 offset:7680
    s_add_u32 m0, s44, 8192
    s_nop 0
    buffer_load_dwordx4 v2, s[8:11], s40 offen lds
    s_add_u32 s40, s40, 393216
    s_add_u32 m0, s44, 16384
    s_nop 0
    buffer_load_dwordx4 v3, s[8:11], s41 offen lds
    s_add_u32 s41, s41, 393216
    v_exp_f32 v64, v64
    v_exp_f32 v65, v65
    s_waitcnt lgkmcnt(8)
    v_mfma_f32_32x32x16_bf16 v[96:111], v[32:35], v[24:27], v[192:207]
    v_exp_f32 v66, v66
    v_exp_f32 v67, v67
    v_exp_f32 v68, v68
    v_mfma_f32_32x32x16_bf16 v[96:111], v[36:39], v[28:31], v[96:111]
    v_exp_f32 v69, v69
    v_exp_f32 v70, v70
    v_exp_f32 v71, v71
    v_mfma_f32_32x32x16_bf16 v[112:127], v[40:43], v[24:27], v[192:207]
    v_exp_f32 v72, v72
    v_exp_f32 v73, v73
    v_exp_f32 v74, v74
    v_mfma_f32_32x32x16_bf16 v[112:127], v[44:47], v[28:31], v[112:127]
    v_exp_f32 v75, v75
    v_exp_f32 v76, v76
    v_exp_f32 v77, v77
    s_waitcnt lgkmcnt(0)
    v_mfma_f32_32x32x16_bf16 v[160:175], v[48:51], v[144:147], v[160:175]
    v_exp_f32 v78, v78
    v_exp_f32 v79, v79
    v_cvt_pk_bf16_f32 v128, v64, v65
    v_mfma_f32_32x32x16_bf16 v[176:191], v[20:23], v[144:147], v[176:191]
    v_cvt_pk_bf16_f32 v129, v66, v67
    v_cvt_pk_bf16_f32 v130, v68, v69
    v_cvt_pk_bf16_f32 v131, v70, v71
    v_mfma_f32_32x32x16_bf16 v[160:175], v[52:55], v[148:151], v[160:175]
    v_exp_f32 v80, v80
    v_exp_f32 v81, v81
    v_exp_f32 v82, v82
    v_mfma_f32_32x32x16_bf16 v[176:191], v[20:23], v[148:151], v[176:191]
    v_exp_f32 v83, v83
    v_exp_f32 v84, v84
    v_exp_f32 v85, v85
    v_mfma_f32_32x32x16_bf16 v[160:175], v[56:59], v[152:155], v[160:175]
    v_exp_f32 v86, v86
    v_exp_f32 v87, v87
    v_cvt_pk_bf16_f32 v132, v72, v73
    v_mfma_f32_32x32x16_bf16 v[176:191], v[20:23], v[152:155], v[176:191]
    v_cvt_pk_bf16_f32 v133, v74, v75
    v_cvt_pk_bf16_f32 v134, v76, v77
    v_cvt_pk_bf16_f32 v135, v78, v79
    v_mfma_f32_32x32x16_bf16 v[160:175], v[60:63], v[156:159], v[160:175]
    v_exp_f32 v88, v88
    v_exp_f32 v89, v89
    v_exp_f32 v90, v90
    v_mfma_f32_32x32x16_bf16 v[176:191], v[20:23], v[156:159], v[176:191]
    v_exp_f32 v91, v91
    v_exp_f32 v92, v92
    v_exp_f32 v93, v93
    v_exp_f32 v94, v94
    v_exp_f32 v95, v95
    v_cvt_pk_bf16_f32 v136, v80, v81
    v_cvt_pk_bf16_f32 v137, v82, v83
    v_cvt_pk_bf16_f32 v138, v84, v85
    v_cvt_pk_bf16_f32 v139, v86, v87
    v_cvt_pk_bf16_f32 v140, v88, v89
    v_cvt_pk_bf16_f32 v141, v90, v91
    v_cvt_pk_bf16_f32 v142, v92, v93
    v_cvt_pk_bf16_f32 v143, v94, v95
    s_waitcnt vmcnt(4)
    s_barrier
    ds_read_b128 v[32:35], v4 offset:0
    ds_read_b128 v[36:39], v5 offset:0
    ds_read_b128 v[40:43], v4 offset:2048
    ds_read_b128 v[44:47], v5 offset:2048
    ds_read_b64_tr_b16 v[48:49], v6 offset:8192
    ds_read_b64_tr_b16 v[50:51], v6 offset:8704
    ds_read_b64_tr_b16 v[52:53], v6 offset:9216
    ds_read_b64_tr_b16 v[54:55], v6 offset:9728
    ds_read_b64_tr_b16 v[56:57], v6 offset:10240
    ds_read_b64_tr_b16 v[58:59], v6 offset:10752
    ds_read_b64_tr_b16 v[60:61], v6 offset:11264
    ds_read_b64_tr_b16 v[62:63], v6 offset:11776
    s_add_u32 m0, s44, 12288
    s_nop 0
    buffer_load_dwordx4 v2, s[8:11], s40 offen lds
    s_add_u32 s40, s40, 393216
    s_add_u32 m0, s44, 20480
    s_nop 0
    buffer_load_dwordx4 v3, s[8:11], s41 offen lds
    s_add_u32 s41, s41, 393216
    v_exp_f32 v96, v96
    v_exp_f32 v97, v97
    s_waitcnt lgkmcnt(8)
    v_mfma_f32_32x32x16_bf16 v[64:79], v[32:35], v[24:27], v[192:207]
    v_exp_f32 v98, v98
    v_exp_f32 v99, v99
    v_exp_f32 v100, v100
    v_mfma_f32_32x32x16_bf16 v[64:79], v[36:39], v[28:31], v[64:79]
    v_exp_f32 v101, v101
    v_exp_f32 v102, v102
    v_exp_f32 v103, v103
    v_mfma_f32_32x32x16_bf16 v[80:95], v[40:43], v[24:27], v[192:207]
    v_exp_f32 v104, v104
    v_exp_f32 v105, v105
    v_exp_f32 v106, v106
    v_mfma_f32_32x32x16_bf16 v[80:95], v[44:47], v[28:31], v[80:95]
    v_exp_f32 v107, v107
    v_exp_f32 v108, v108
    v_exp_f32 v109, v109
    s_waitcnt lgkmcnt(0)
    v_mfma_f32_32x32x16_bf16 v[160:175], v[48:51], v[128:131], v[160:175]
    v_exp_f32 v110, v110
    v_exp_f32 v111, v111
    v_cvt_pk_bf16_f32 v144, v96, v97
    v_mfma_f32_32x32x16_bf16 v[176:191], v[20:23], v[128:131], v[176:191]
    v_cvt_pk_bf16_f32 v145, v98, v99
    v_cvt_pk_bf16_f32 v146, v100, v101
    v_cvt_pk_bf16_f32 v147, v102, v103
    v_mfma_f32_32x32x16_bf16 v[160:175], v[52:55], v[132:135], v[160:175]
    v_exp_f32 v112, v112
    v_exp_f32 v113, v113
    v_exp_f32 v114, v114
    v_mfma_f32_32x32x16_bf16 v[176:191], v[20:23], v[132:135], v[176:191]
    v_exp_f32 v115, v115
    v_exp_f32 v116, v116
    v_exp_f32 v117, v117
    v_mfma_f32_32x32x16_bf16 v[160:175], v[56:59], v[136:139], v[160:175]
    v_exp_f32 v118, v118
    v_exp_f32 v119, v119
    v_cvt_pk_bf16_f32 v148, v104, v105
    v_mfma_f32_32x32x16_bf16 v[176:191], v[20:23], v[136:139], v[176:191]
    v_cvt_pk_bf16_f32 v149, v106, v107
    v_cvt_pk_bf16_f32 v150, v108, v109
    v_cvt_pk_bf16_f32 v151, v110, v111
    v_mfma_f32_32x32x16_bf16 v[160:175], v[60:63], v[140:143], v[160:175]
    v_exp_f32 v120, v120
    v_exp_f32 v121, v121
    v_exp_f32 v122, v122
    v_mfma_f32_32x32x16_bf16 v[176:191], v[20:23], v[140:143], v[176:191]
    v_exp_f32 v123, v123
    v_exp_f32 v124, v124
    v_exp_f32 v125, v125
    v_exp_f32 v126, v126
    v_exp_f32 v127, v127
    v_cvt_pk_bf16_f32 v152, v112, v113
    v_cvt_pk_bf16_f32 v153, v114, v115
    v_cvt_pk_bf16_f32 v154, v116, v117
    v_cvt_pk_bf16_f32 v155, v118, v119
    v_cvt_pk_bf16_f32 v156, v120, v121
    v_cvt_pk_bf16_f32 v157, v122, v123
    v_cvt_pk_bf16_f32 v158, v124, v125
    v_cvt_pk_bf16_f32 v159, v126, v127
    s_waitcnt vmcnt(4)
    s_barrier
    ds_read_b128 v[32:35], v4 offset:4096
    ds_read_b128 v[36:39], v5 offset:4096
    ds_read_b128 v[40:43], v4 offset:6144
    ds_read_b128 v[44:47], v5 offset:6144
    ds_read_b64_tr_b16 v[48:49], v6 offset:12288
    ds_read_b64_tr_b16 v[50:51], v6 offset:12800
    ds_read_b64_tr_b16 v[52:53], v6 offset:13312
    ds_read_b64_tr_b16 v[54:55], v6 offset:13824
    ds_read_b64_tr_b16 v[56:57], v6 offset:14336
    ds_read_b64_tr_b16 v[58:59], v6 offset:14848
    ds_read_b64_tr_b16 v[60:61], v6 offset:15360
    ds_read_b64_tr_b16 v[62:63], v6 offset:15872
    s_add_u32 m0, s44, 0
    s_nop 0
    buffer_load_dwordx4 v2, s[8:11], s40 offen lds
    s_add_u32 s40, s40, 393216
    s_add_u32 m0, s44, 24576
    s_nop 0
    buffer_load_dwordx4 v3, s[8:11], s41 offen lds
    s_add_u32 s41, s41, 393216
    v_exp_f32 v64, v64
    v_exp_f32 v65, v65
    s_waitcnt lgkmcnt(8)
    v_mfma_f32_32x32x16_bf16 v[96:111], v[32:35], v[24:27], v[192:207]
    v_exp_f32 v66, v66
    v_exp_f32 v67, v67
    v_exp_f32 v68, v68
    v_mfma_f32_32x32x16_bf16 v[96:111], v[36:39], v[28:31], v[96:111]
    v_exp_f32 v69, v69
    v_exp_f32 v70, v70
    v_exp_f32 v71, v71
    v_mfma_f32_32x32x16_bf16 v[112:127], v[40:43], v[24:27], v[192:207]
    v_exp_f32 v72, v72
    v_exp_f32 v73, v73
    v_exp_f32 v74, v74
    v_mfma_f32_32x32x16_bf16 v[112:127], v[44:47], v[28:31], v[112:127]
    v_exp_f32 v75, v75
    v_exp_f32 v76, v76
    v_exp_f32 v77, v77
    s_waitcnt lgkmcnt(0)
    v_mfma_f32_32x32x16_bf16 v[160:175], v[48:51], v[144:147], v[160:175]
    v_exp_f32 v78, v78
    v_exp_f32 v79, v79
    v_cvt_pk_bf16_f32 v128, v64, v65
    v_mfma_f32_32x32x16_bf16 v[176:191], v[20:23], v[144:147], v[176:191]
    v_cvt_pk_bf16_f32 v129, v66, v67
    v_cvt_pk_bf16_f32 v130, v68, v69
    v_cvt_pk_bf16_f32 v131, v70, v71
    v_mfma_f32_32x32x16_bf16 v[160:175], v[52:55], v[148:151], v[160:175]
    v_exp_f32 v80, v80
    v_exp_f32 v81, v81
    v_exp_f32 v82, v82
    v_mfma_f32_32x32x16_bf16 v[176:191], v[20:23], v[148:151], v[176:191]
    v_exp_f32 v83, v83
    v_exp_f32 v84, v84
    v_exp_f32 v85, v85
    v_mfma_f32_32x32x16_bf16 v[160:175], v[56:59], v[152:155], v[160:175]
    v_exp_f32 v86, v86
    v_exp_f32 v87, v87
    v_cvt_pk_bf16_f32 v132, v72, v73
    v_mfma_f32_32x32x16_bf16 v[176:191], v[20:23], v[152:155], v[176:191]
    v_cvt_pk_bf16_f32 v133, v74, v75
    v_cvt_pk_bf16_f32 v134, v76, v77
    v_cvt_pk_bf16_f32 v135, v78, v79
    v_mfma_f32_32x32x16_bf16 v[160:175], v[60:63], v[156:159], v[160:175]
    v_exp_f32 v88, v88
    v_exp_f32 v89, v89
    v_exp_f32 v90, v90
    v_mfma_f32_32x32x16_bf16 v[176:191], v[20:23], v[156:159], v[176:191]
    v_exp_f32 v91, v91
    v_exp_f32 v92, v92
    v_exp_f32 v93, v93
    v_exp_f32 v94, v94
    v_exp_f32 v95, v95
    v_cvt_pk_bf16_f32 v136, v80, v81
    v_cvt_pk_bf16_f32 v137, v82, v83
    v_cvt_pk_bf16_f32 v138, v84, v85
    v_cvt_pk_bf16_f32 v139, v86, v87
    v_cvt_pk_bf16_f32 v140, v88, v89
    v_cvt_pk_bf16_f32 v141, v90, v91
    v_cvt_pk_bf16_f32 v142, v92, v93
    v_cvt_pk_bf16_f32 v143, v94, v95
    s_add_u32 s45, s45, 1
    s_cmp_lt_u32 s45, 7
    s_cbranch_scc1 mid_kernel_loop3
    s_waitcnt vmcnt(4)
    s_barrier
    ds_read_b128 v[32:35], v4 offset:8192
    ds_read_b128 v[36:39], v5 offset:8192
    ds_read_b128 v[40:43], v4 offset:10240
    ds_read_b128 v[44:47], v5 offset:10240
    ds_read_b64_tr_b16 v[48:49], v6 offset:0
    ds_read_b64_tr_b16 v[50:51], v6 offset:512
    ds_read_b64_tr_b16 v[52:53], v6 offset:1024
    ds_read_b64_tr_b16 v[54:55], v6 offset:1536
    ds_read_b64_tr_b16 v[56:57], v6 offset:2048
    ds_read_b64_tr_b16 v[58:59], v6 offset:2560
    ds_read_b64_tr_b16 v[60:61], v6 offset:3072
    ds_read_b64_tr_b16 v[62:63], v6 offset:3584
    s_add_u32 m0, s44, 4096
    s_nop 0
    buffer_load_dwordx4 v2, s[8:11], s40 offen lds
    s_add_u32 s40, s40, 393216
    s_add_u32 m0, s44, 28672
    s_nop 0
    buffer_load_dwordx4 v3, s[8:11], s41 offen lds
    s_add_u32 s41, s41, 393216
    v_exp_f32 v96, v96
    v_exp_f32 v97, v97
    s_waitcnt lgkmcnt(8)
    v_mfma_f32_32x32x16_bf16 v[64:79], v[32:35], v[24:27], v[192:207]
    v_exp_f32 v98, v98
    v_exp_f32 v99, v99
    v_exp_f32 v100, v100
    v_mfma_f32_32x32x16_bf16 v[64:79], v[36:39], v[28:31], v[64:79]
    v_exp_f32 v101, v101
    v_exp_f32 v102, v102
    v_exp_f32 v103, v103
    v_mfma_f32_32x32x16_bf16 v[80:95], v[40:43], v[24:27], v[192:207]
    v_exp_f32 v104, v104
    v_exp_f32 v105, v105
    v_exp_f32 v106, v106
    v_mfma_f32_32x32x16_bf16 v[80:95], v[44:47], v[28:31], v[80:95]
    v_exp_f32 v107, v107
    v_exp_f32 v108, v108
    v_exp_f32 v109, v109
    s_waitcnt lgkmcnt(0)
    v_mfma_f32_32x32x16_bf16 v[160:175], v[48:51], v[128:131], v[160:175]
    v_exp_f32 v110, v110
    v_exp_f32 v111, v111
    v_cvt_pk_bf16_f32 v144, v96, v97
    v_mfma_f32_32x32x16_bf16 v[176:191], v[20:23], v[128:131], v[176:191]
    v_cvt_pk_bf16_f32 v145, v98, v99
    v_cvt_pk_bf16_f32 v146, v100, v101
    v_cvt_pk_bf16_f32 v147, v102, v103
    v_mfma_f32_32x32x16_bf16 v[160:175], v[52:55], v[132:135], v[160:175]
    v_exp_f32 v112, v112
    v_exp_f32 v113, v113
    v_exp_f32 v114, v114
    v_mfma_f32_32x32x16_bf16 v[176:191], v[20:23], v[132:135], v[176:191]
    v_exp_f32 v115, v115
    v_exp_f32 v116, v116
    v_exp_f32 v117, v117
    v_mfma_f32_32x32x16_bf16 v[160:175], v[56:59], v[136:139], v[160:175]
    v_exp_f32 v118, v118
    v_exp_f32 v119, v119
    v_cvt_pk_bf16_f32 v148, v104, v105
    v_mfma_f32_32x32x16_bf16 v[176:191], v[20:23], v[136:139], v[176:191]
    v_cvt_pk_bf16_f32 v149, v106, v107
    v_cvt_pk_bf16_f32 v150, v108, v109
    v_cvt_pk_bf16_f32 v151, v110, v111
    v_mfma_f32_32x32x16_bf16 v[160:175], v[60:63], v[140:143], v[160:175]
    v_exp_f32 v120, v120
    v_exp_f32 v121, v121
    v_exp_f32 v122, v122
    v_mfma_f32_32x32x16_bf16 v[176:191], v[20:23], v[140:143], v[176:191]
    v_exp_f32 v123, v123
    v_exp_f32 v124, v124
    v_exp_f32 v125, v125
    v_exp_f32 v126, v126
    v_exp_f32 v127, v127
    v_cvt_pk_bf16_f32 v152, v112, v113
    v_cvt_pk_bf16_f32 v153, v114, v115
    v_cvt_pk_bf16_f32 v154, v116, v117
    v_cvt_pk_bf16_f32 v155, v118, v119
    v_cvt_pk_bf16_f32 v156, v120, v121
    v_cvt_pk_bf16_f32 v157, v122, v123
    v_cvt_pk_bf16_f32 v158, v124, v125
    v_cvt_pk_bf16_f32 v159, v126, v127
    s_waitcnt vmcnt(4)
    s_barrier
    ds_read_b128 v[32:35], v4 offset:12288
    ds_read_b128 v[36:39], v5 offset:12288
    ds_read_b128 v[40:43], v4 offset:14336
    ds_read_b128 v[44:47], v5 offset:14336
    ds_read_b64_tr_b16 v[48:49], v6 offset:4096
    ds_read_b64_tr_b16 v[50:51], v6 offset:4608
    ds_read_b64_tr_b16 v[52:53], v6 offset:5120
    ds_read_b64_tr_b16 v[54:55], v6 offset:5632
    ds_read_b64_tr_b16 v[56:57], v6 offset:6144
    ds_read_b64_tr_b16 v[58:59], v6 offset:6656
    ds_read_b64_tr_b16 v[60:61], v6 offset:7168
    ds_read_b64_tr_b16 v[62:63], v6 offset:7680
    s_add_u32 m0, s44, 8192
    s_nop 0
    buffer_load_dwordx4 v2, s[8:11], s40 offen lds
    s_add_u32 s40, s40, 393216
    s_add_u32 m0, s44, 16384
    s_nop 0
    buffer_load_dwordx4 v3, s[8:11], s41 offen lds
    s_add_u32 s41, s41, 393216
    v_exp_f32 v64, v64
    v_exp_f32 v65, v65
    s_waitcnt lgkmcnt(8)
    v_mfma_f32_32x32x16_bf16 v[96:111], v[32:35], v[24:27], v[192:207]
    v_exp_f32 v66, v66
    v_exp_f32 v67, v67
    v_exp_f32 v68, v68
    v_mfma_f32_32x32x16_bf16 v[96:111], v[36:39], v[28:31], v[96:111]
    v_exp_f32 v69, v69
    v_exp_f32 v70, v70
    v_exp_f32 v71, v71
    v_mfma_f32_32x32x16_bf16 v[112:127], v[40:43], v[24:27], v[192:207]
    v_exp_f32 v72, v72
    v_exp_f32 v73, v73
    v_exp_f32 v74, v74
    v_mfma_f32_32x32x16_bf16 v[112:127], v[44:47], v[28:31], v[112:127]
    v_exp_f32 v75, v75
    v_exp_f32 v76, v76
    v_exp_f32 v77, v77
    s_waitcnt lgkmcnt(0)
    v_mfma_f32_32x32x16_bf16 v[160:175], v[48:51], v[144:147], v[160:175]
    v_exp_f32 v78, v78
    v_exp_f32 v79, v79
    v_cvt_pk_bf16_f32 v128, v64, v65
    v_mfma_f32_32x32x16_bf16 v[176:191], v[20:23], v[144:147], v[176:191]
    v_cvt_pk_bf16_f32 v129, v66, v67
    v_cvt_pk_bf16_f32 v130, v68, v69
    v_cvt_pk_bf16_f32 v131, v70, v71
    v_mfma_f32_32x32x16_bf16 v[160:175], v[52:55], v[148:151], v[160:175]
    v_exp_f32 v80, v80
    v_exp_f32 v81, v81
    v_exp_f32 v82, v82
    v_mfma_f32_32x32x16_bf16 v[176:191], v[20:23], v[148:151], v[176:191]
    v_exp_f32 v83, v83
    v_exp_f32 v84, v84
    v_exp_f32 v85, v85
    v_mfma_f32_32x32x16_bf16 v[160:175], v[56:59], v[152:155], v[160:175]
    v_exp_f32 v86, v86
    v_exp_f32 v87, v87
    v_cvt_pk_bf16_f32 v132, v72, v73
    v_mfma_f32_32x32x16_bf16 v[176:191], v[20:23], v[152:155], v[176:191]
    v_cvt_pk_bf16_f32 v133, v74, v75
    v_cvt_pk_bf16_f32 v134, v76, v77
    v_cvt_pk_bf16_f32 v135, v78, v79
    v_mfma_f32_32x32x16_bf16 v[160:175], v[60:63], v[156:159], v[160:175]
    v_exp_f32 v88, v88
    v_exp_f32 v89, v89
    v_exp_f32 v90, v90
    v_mfma_f32_32x32x16_bf16 v[176:191], v[20:23], v[156:159], v[176:191]
    v_exp_f32 v91, v91
    v_exp_f32 v92, v92
    v_exp_f32 v93, v93
    v_exp_f32 v94, v94
    v_exp_f32 v95, v95
    v_cvt_pk_bf16_f32 v136, v80, v81
    v_cvt_pk_bf16_f32 v137, v82, v83
    v_cvt_pk_bf16_f32 v138, v84, v85
    v_cvt_pk_bf16_f32 v139, v86, v87
    v_cvt_pk_bf16_f32 v140, v88, v89
    v_cvt_pk_bf16_f32 v141, v90, v91
    v_cvt_pk_bf16_f32 v142, v92, v93
    v_cvt_pk_bf16_f32 v143, v94, v95
    s_waitcnt vmcnt(4)
    s_barrier
    ds_read_b64_tr_b16 v[48:49], v6 offset:8192
    ds_read_b64_tr_b16 v[50:51], v6 offset:8704
    ds_read_b64_tr_b16 v[52:53], v6 offset:9216
    ds_read_b64_tr_b16 v[54:55], v6 offset:9728
    ds_read_b64_tr_b16 v[56:57], v6 offset:10240
    ds_read_b64_tr_b16 v[58:59], v6 offset:10752
    ds_read_b64_tr_b16 v[60:61], v6 offset:11264
    ds_read_b64_tr_b16 v[62:63], v6 offset:11776
    s_add_u32 m0, s44, 12288
    s_nop 0
    buffer_load_dwordx4 v2, s[8:11], s40 offen lds
    s_add_u32 s40, s40, 393216
    s_add_u32 m0, s44, 20480
    s_nop 0
    buffer_load_dwordx4 v3, s[8:11], s41 offen lds
    s_add_u32 s41, s41, 393216
    v_exp_f32 v96, v96
    v_exp_f32 v97, v97
    s_waitcnt lgkmcnt(0)
    v_mfma_f32_32x32x16_bf16 v[160:175], v[48:51], v[128:131], v[160:175]
    v_exp_f32 v98, v98
    v_exp_f32 v99, v99
    v_exp_f32 v100, v100
    v_exp_f32 v101, v101
    v_exp_f32 v102, v102
    v_mfma_f32_32x32x16_bf16 v[176:191], v[20:23], v[128:131], v[176:191]
    v_exp_f32 v103, v103
    v_exp_f32 v104, v104
    v_exp_f32 v105, v105
    v_exp_f32 v106, v106
    v_exp_f32 v107, v107
    v_mfma_f32_32x32x16_bf16 v[160:175], v[52:55], v[132:135], v[160:175]
    v_exp_f32 v108, v108
    v_exp_f32 v109, v109
    v_exp_f32 v110, v110
    v_exp_f32 v111, v111
    v_cvt_pk_bf16_f32 v144, v96, v97
    v_mfma_f32_32x32x16_bf16 v[176:191], v[20:23], v[132:135], v[176:191]
    v_cvt_pk_bf16_f32 v145, v98, v99
    v_cvt_pk_bf16_f32 v146, v100, v101
    v_cvt_pk_bf16_f32 v147, v102, v103
    v_exp_f32 v112, v112
    v_exp_f32 v113, v113
    v_mfma_f32_32x32x16_bf16 v[160:175], v[56:59], v[136:139], v[160:175]
    v_exp_f32 v114, v114
    v_exp_f32 v115, v115
    v_exp_f32 v116, v116
    v_exp_f32 v117, v117
    v_exp_f32 v118, v118
    v_mfma_f32_32x32x16_bf16 v[176:191], v[20:23], v[136:139], v[176:191]
    v_exp_f32 v119, v119
    v_cvt_pk_bf16_f32 v148, v104, v105
    v_cvt_pk_bf16_f32 v149, v106, v107
    v_cvt_pk_bf16_f32 v150, v108, v109
    v_cvt_pk_bf16_f32 v151, v110, v111
    v_mfma_f32_32x32x16_bf16 v[160:175], v[60:63], v[140:143], v[160:175]
    v_exp_f32 v120, v120
    v_exp_f32 v121, v121
    v_exp_f32 v122, v122
    v_exp_f32 v123, v123
    v_exp_f32 v124, v124
    v_mfma_f32_32x32x16_bf16 v[176:191], v[20:23], v[140:143], v[176:191]
    v_exp_f32 v125, v125
    v_exp_f32 v126, v126
    v_exp_f32 v127, v127
    v_cvt_pk_bf16_f32 v152, v112, v113
    v_cvt_pk_bf16_f32 v153, v114, v115
    v_cvt_pk_bf16_f32 v154, v116, v117
    v_cvt_pk_bf16_f32 v155, v118, v119
    v_cvt_pk_bf16_f32 v156, v120, v121
    v_cvt_pk_bf16_f32 v157, v122, v123
    v_cvt_pk_bf16_f32 v158, v124, v125
    v_cvt_pk_bf16_f32 v159, v126, v127
    s_waitcnt vmcnt(4)
    s_barrier
    ds_read_b64_tr_b16 v[48:49], v6 offset:12288
    ds_read_b64_tr_b16 v[50:51], v6 offset:12800
    ds_read_b64_tr_b16 v[52:53], v6 offset:13312
    ds_read_b64_tr_b16 v[54:55], v6 offset:13824
    ds_read_b64_tr_b16 v[56:57], v6 offset:14336
    ds_read_b64_tr_b16 v[58:59], v6 offset:14848
    ds_read_b64_tr_b16 v[60:61], v6 offset:15360
    ds_read_b64_tr_b16 v[62:63], v6 offset:15872
    s_waitcnt lgkmcnt(0)
    v_mfma_f32_32x32x16_bf16 v[160:175], v[48:51], v[144:147], v[160:175]
    v_mfma_f32_32x32x16_bf16 v[176:191], v[20:23], v[144:147], v[176:191]
    v_mfma_f32_32x32x16_bf16 v[160:175], v[52:55], v[148:151], v[160:175]
    v_mfma_f32_32x32x16_bf16 v[176:191], v[20:23], v[148:151], v[176:191]
    v_mfma_f32_32x32x16_bf16 v[160:175], v[56:59], v[152:155], v[160:175]
    v_mfma_f32_32x32x16_bf16 v[176:191], v[20:23], v[152:155], v[176:191]
    v_mfma_f32_32x32x16_bf16 v[160:175], v[60:63], v[156:159], v[160:175]
    v_mfma_f32_32x32x16_bf16 v[176:191], v[20:23], v[156:159], v[176:191]
    s_nop 7
    s_nop 7
    s_mov_b32 s7, 0x5f800000
    v_cmp_nlt_f32 s[34:35], v176, s7
    s_cmp_lg_u64 s[34:35], 0
    s_cselect_b32 s7, 1, 0
    v_mov_b32 v9, s7
    s_lshl_b32 s7, s4, 2
    s_add_u32 s7, s7, 40960
    v_mov_b32 v11, s7
    ds_write_b32 v11, v9
    s_waitcnt vmcnt(0) lgkmcnt(0)
    s_barrier
    v_mov_b32 v11, 40960
    ds_read_b128 v[32:35], v11
    s_waitcnt lgkmcnt(0)
    v_or3_b32 v9, v32, v33, v34
    v_or_b32 v9, v9, v35
    s_nop 0
    v_readfirstlane_b32 s7, v9
    s_cmp_eq_u32 s7, 0
    s_cbranch_scc1 mid_kernel_done4
    v_mov_b32 v160, 0
    v_mov_b32 v161, 0
    v_mov_b32 v162, 0
    v_mov_b32 v163, 0
    v_mov_b32 v164, 0
    v_mov_b32 v165, 0
    v_mov_b32 v166, 0
    v_mov_b32 v167, 0
    v_mov_b32 v168, 0
    v_mov_b32 v169, 0
    v_mov_b32 v170, 0
    v_mov_b32 v171, 0
    v_mov_b32 v172, 0
    v_mov_b32 v173, 0
    v_mov_b32 v174, 0
    v_mov_b32 v175, 0
    v_mov_b32 v176, 0
    v_mov_b32 v177, 0
    v_mov_b32 v178, 0
    v_mov_b32 v179, 0
    v_mov_b32 v180, 0
    v_mov_b32 v181, 0
    v_mov_b32 v182, 0
    v_mov_b32 v183, 0
    v_mov_b32 v184, 0
    v_mov_b32 v185, 0
    v_mov_b32 v186, 0
    v_mov_b32 v187, 0
    v_mov_b32 v188, 0
    v_mov_b32 v189, 0
    v_mov_b32 v190, 0
    v_mov_b32 v191, 0
    v_mov_b32 v10, 0
    s_mov_b32 s40, 0
    s_mov_b32 s41, 0
    s_mov_b32 s45, 0
    s_mov_b64 s[34:35], 0
    s_add_u32 m0, s44, 0
    s_nop 0
    buffer_load_dwordx4 v2, s[8:11], s40 offen lds
    s_add_u32 s40, s40, 393216
    s_add_u32 m0, s44, 4096
    s_nop 0
    buffer_load_dwordx4 v2, s[8:11], s40 offen lds
    s_add_u32 s40, s40, 393216
    s_add_u32 m0, s44, 8192
    s_nop 0
    buffer_load_dwordx4 v2, s[8:11], s40 offen lds
    s_add_u32 s40, s40, 393216
    s_add_u32 m0, s44, 16384
    s_nop 0
    buffer_load_dwordx4 v3, s[8:11], s41 offen lds
    s_add_u32 s41, s41, 393216
    s_add_u32 m0, s44, 12288
    s_nop 0
    buffer_load_dwordx4 v2, s[8:11], s40 offen lds
    s_add_u32 s40, s40, 393216
    s_add_u32 m0, s44, 20480
    s_nop 0
    buffer_load_dwordx4 v3, s[8:11], s41 offen lds
    s_add_u32 s41, s41, 393216
    s_waitcnt vmcnt(4)
    s_barrier
    ds_read_b128 v[32:35], v4 offset:0
    ds_read_b128 v[36:39], v5 offset:0
    ds_read_b128 v[40:43], v4 offset:2048
    ds_read_b128 v[44:47], v5 offset:2048
    s_waitcnt lgkmcnt(0)
    v_mfma_f32_32x32x16_bf16 v[64:79], v[32:35], v[24:27], 0
    v_mfma_f32_32x32x16_bf16 v[64:79], v[36:39], v[28:31], v[64:79]
    v_mfma_f32_32x32x16_bf16 v[80:95], v[40:43], v[24:27], 0
    v_mfma_f32_32x32x16_bf16 v[80:95], v[44:47], v[28:31], v[80:95]
    s_nop 7
    s_nop 3
    s_waitcnt vmcnt(4)
    s_barrier
    ds_read_b128 v[32:35], v4 offset:4096
    ds_read_b128 v[36:39], v5 offset:4096
    ds_read_b128 v[40:43], v4 offset:6144
    ds_read_b128 v[44:47], v5 offset:6144
    s_add_u32 m0, s44, 0
    s_nop 0
    buffer_load_dwordx4 v2, s[8:11], s40 offen lds
    s_add_u32 s40, s40, 393216
    s_add_u32 m0, s44, 24576
    s_nop 0
    buffer_load_dwordx4 v3, s[8:11], s41 offen lds
    s_add_u32 s41, s41, 393216
    v_max3_f32 v11, v64, v65, v66
    v_max3_f32 v9, v79, v80, v81
    v_max3_f32 v11, v11, v67, v68
    v_max3_f32 v9, v9, v82, v83
    v_max3_f32 v11, v11, v69, v70
    v_max3_f32 v9, v9, v84, v85
    v_max3_f32 v11, v11, v71, v72
    v_max3_f32 v9, v9, v86, v87
    v_max3_f32 v11, v11, v73, v74
    v_max3_f32 v9, v9, v88, v89
    v_max3_f32 v11, v11, v75, v76
    v_max3_f32 v9, v9, v90, v91
    v_max3_f32 v11, v11, v77, v78
    v_max3_f32 v9, v9, v92, v93
    v_max3_f32 v9, v9, v94, v95
    v_max_f32 v11, v11, v9
    v_mov_b32 v9, v11
    s_nop 1
    v_permlane32_swap_b32 v11, v9
    v_max_f32 v11, v11, v9
    v_sub_f32 v64, v64, v11
    v_sub_f32 v65, v65, v11
    v_sub_f32 v66, v66, v11
    v_sub_f32 v67, v67, v11
    v_sub_f32 v68, v68, v11
    v_sub_f32 v69, v69, v11
    v_sub_f32 v70, v70, v11
    v_sub_f32 v71, v71, v11
    v_sub_f32 v72, v72, v11
    v_sub_f32 v73, v73, v11
    v_sub_f32 v74, v74, v11
    v_sub_f32 v75, v75, v11
    v_sub_f32 v76, v76, v11
    v_sub_f32 v77, v77, v11
    v_sub_f32 v78, v78, v11
    v_sub_f32 v79, v79, v11
    v_sub_f32 v80, v80, v11
    v_sub_f32 v81, v81, v11
    v_sub_f32 v82, v82, v11
    v_sub_f32 v83, v83, v11
    v_sub_f32 v84, v84, v11
    v_sub_f32 v85, v85, v11
    v_sub_f32 v86, v86, v11
    v_sub_f32 v87, v87, v11
    v_sub_f32 v88, v88, v11
    v_sub_f32 v89, v89, v11
    v_sub_f32 v90, v90, v11
    v_sub_f32 v91, v91, v11
    v_sub_f32 v92, v92, v11
    v_sub_f32 v93, v93, v11
    v_sub_f32 v94, v94, v11
    v_sub_f32 v95, v95, v11
    v_add_f32 v10, v10, v11
    v_exp_f32 v17, -v11
    v_sub_f32 v192, 0, v10
    v_sub_f32 v193, 0, v10
    v_sub_f32 v194, 0, v10
    v_sub_f32 v195, 0, v10
    v_sub_f32 v196, 0, v10
    v_sub_f32 v197, 0, v10
    v_sub_f32 v198, 0, v10
    v_sub_f32 v199, 0, v10
    v_sub_f32 v200, 0, v10
    v_sub_f32 v201, 0, v10
    v_sub_f32 v202, 0, v10
    v_sub_f32 v203, 0, v10
    v_sub_f32 v204, 0, v10
    v_sub_f32 v205, 0, v10
    v_sub_f32 v206, 0, v10
    v_sub_f32 v207, 0, v10
mid_kernel_nochg5:
    v_exp_f32 v64, v64
    v_exp_f32 v65, v65
    s_waitcnt lgkmcnt(0)
    v_mfma_f32_32x32x16_bf16 v[96:111], v[32:35], v[24:27], v[192:207]
    v_exp_f32 v66, v66
    v_exp_f32 v67, v67
    v_exp_f32 v68, v68
    v_exp_f32 v69, v69
    v_exp_f32 v70, v70
    v_exp_f32 v71, v71
    v_exp_f32 v72, v72
    v_exp_f32 v73, v73
    v_exp_f32 v74, v74
    v_exp_f32 v75, v75
    v_mfma_f32_32x32x16_bf16 v[96:111], v[36:39], v[28:31], v[96:111]
    v_exp_f32 v76, v76
    v_exp_f32 v77, v77
    v_exp_f32 v78, v78
    v_exp_f32 v79, v79
    v_cvt_pk_bf16_f32 v128, v64, v65
    v_cvt_pk_bf16_f32 v129, v66, v67
    v_cvt_pk_bf16_f32 v130, v68, v69
    v_cvt_pk_bf16_f32 v131, v70, v71
    v_exp_f32 v80, v80
    v_exp_f32 v81, v81
    v_mfma_f32_32x32x16_bf16 v[112:127], v[40:43], v[24:27], v[192:207]
    v_exp_f32 v82, v82
    v_exp_f32 v83, v83
    v_exp_f32 v84, v84
    v_exp_f32 v85, v85
    v_exp_f32 v86, v86
    v_exp_f32 v87, v87
    v_cvt_pk_bf16_f32 v132, v72, v73
    v_cvt_pk_bf16_f32 v133, v74, v75
    v_cvt_pk_bf16_f32 v134, v76, v77
    v_cvt_pk_bf16_f32 v135, v78, v79
    v_mfma_f32_32x32x16_bf16 v[112:127], v[44:47], v[28:31], v[112:127]
    v_exp_f32 v88, v88
    v_exp_f32 v89, v89
    v_exp_f32 v90, v90
    v_exp_f32 v91, v91
    v_exp_f32 v92, v92
    v_exp_f32 v93, v93
    v_exp_f32 v94, v94
    v_exp_f32 v95, v95
    v_cvt_pk_bf16_f32 v136, v80, v81
    v_cvt_pk_bf16_f32 v137, v82, v83
    v_cvt_pk_bf16_f32 v138, v84, v85
    v_cvt_pk_bf16_f32 v139, v86, v87
    v_cvt_pk_bf16_f32 v140, v88, v89
    v_cvt_pk_bf16_f32 v141, v90, v91
    v_cvt_pk_bf16_f32 v142, v92, v93
    v_cvt_pk_bf16_f32 v143, v94, v95
mid_kernel_loop6:
    s_waitcnt vmcnt(4)
    s_barrier
    ds_read_b128 v[32:35], v4 offset:8192
    ds_read_b128 v[36:39], v5 offset:8192
    ds_read_b128 v[40:43], v4 offset:10240
    ds_read_b128 v[44:47], v5 offset:10240
    ds_read_b64_tr_b16 v[48:49], v6 offset:0
    ds_read_b64_tr_b16 v[50:51], v6 offset:512
    ds_read_b64_tr_b16 v[52:53], v6 offset:1024
    ds_read_b64_tr_b16 v[54:55], v6 offset:1536
    ds_read_b64_tr_b16 v[56:57], v6 offset:2048
    ds_read_b64_tr_b16 v[58:59], v6 offset:2560
    ds_read_b64_tr_b16 v[60:61], v6 offset:3072
    ds_read_b64_tr_b16 v[62:63], v6 offset:3584
    s_add_u32 m0, s44, 4096
    s_nop 0
    buffer_load_dwordx4 v2, s[8:11], s40 offen lds
    s_add_u32 s40, s40, 393216
    s_add_u32 m0, s44, 28672
    s_nop 0
    buffer_load_dwordx4 v3, s[8:11], s41 offen lds
    s_add_u32 s41, s41, 393216
    s_cmp_eq_u64 s[34:35], 0
    s_cbranch_scc1 mid_kernel_skip7
    v_mul_f32 v160, v160, v17
    v_mul_f32 v161, v161, v17
    v_mul_f32 v162, v162, v17
    v_mul_f32 v163, v163, v17
    v_mul_f32 v164, v164, v17
    v_mul_f32 v165, v165, v17
    v_mul_f32 v166, v166, v17
    v_mul_f32 v167, v167, v17
    v_mul_f32 v168, v168, v17
    v_mul_f32 v169, v169, v17
    v_mul_f32 v170, v170, v17
    v_mul_f32 v171, v171, v17
    v_mul_f32 v172, v172, v17
    v_mul_f32 v173, v173, v17
    v_mul_f32 v174, v174, v17
    v_mul_f32 v175, v175, v17
    v_mul_f32 v176, v176, v17
mid_kernel_skip7:
    v_max3_f32 v11, v96, v97, v98
    v_max3_f32 v9, v111, v112, v113
    v_max3_f32 v11, v11, v99, v100
    v_max3_f32 v9, v9, v114, v115
    v_max3_f32 v11, v11, v101, v102
    v_max3_f32 v9, v9, v116, v117
    v_max3_f32 v11, v11, v103, v104
    v_max3_f32 v9, v9, v118, v119
    v_max3_f32 v11, v11, v105, v106
    v_max3_f32 v9, v9, v120, v121
    v_max3_f32 v11, v11, v107, v108
    v_max3_f32 v9, v9, v122, v123
    v_max3_f32 v11, v11, v109, v110
    v_max3_f32 v9, v9, v124, v125
    v_max3_f32 v9, v9, v126, v127
    v_max_f32 v11, v11, v9
    v_mov_b32 v9, v11
    s_nop 1
    v_permlane32_swap_b32 v11, v9
    v_max_f32 v11, v11, v9
    v_cmp_lt_f32 s[34:35], s31, v11
    v_max_f32 v11, 0, v11
    s_cmp_eq_u64 s[34:35], 0
    s_cbranch_scc1 mid_kernel_nochg8
    v_sub_f32 v96, v96, v11
    v_sub_f32 v97, v97, v11
    v_sub_f32 v98, v98, v11
    v_sub_f32 v99, v99, v11
    v_sub_f32 v100, v100, v11
    v_sub_f32 v101, v101, v11
    v_sub_f32 v102, v102, v11
    v_sub_f32 v103, v103, v11
    v_sub_f32 v104, v104, v11
    v_sub_f32 v105, v105, v11
    v_sub_f32 v106, v106, v11
    v_sub_f32 v107, v107, v11
    v_sub_f32 v108, v108, v11
    v_sub_f32 v109, v109, v11
    v_sub_f32 v110, v110, v11
    v_sub_f32 v111, v111, v11
    v_sub_f32 v112, v112, v11
    v_sub_f32 v113, v113, v11
    v_sub_f32 v114, v114, v11
    v_sub_f32 v115, v115, v11
    v_sub_f32 v116, v116, v11
    v_sub_f32 v117, v117, v11
    v_sub_f32 v118, v118, v11
    v_sub_f32 v119, v119, v11
    v_sub_f32 v120, v120, v11
    v_sub_f32 v121, v121, v11
    v_sub_f32 v122, v122, v11
    v_sub_f32 v123, v123, v11
    v_sub_f32 v124, v124, v11
    v_sub_f32 v125, v125, v11
    v_sub_f32 v126, v126, v11
    v_sub_f32 v127, v127, v11
    v_add_f32 v10, v10, v11
    v_exp_f32 v17, -v11
    v_sub_f32 v192, 0, v10
    v_sub_f32 v193, 0, v10
    v_sub_f32 v194, 0, v10
    v_sub_f32 v195, 0, v10
    v_sub_f32 v196, 0, v10
    v_sub_f32 v197, 0, v10
    v_sub_f32 v198, 0, v10
    v_sub_f32 v199, 0, v10
    v_sub_f32 v200, 0, v10
    v_sub_f32 v201, 0, v10
    v_sub_f32 v202, 0, v10
    v_sub_f32 v203, 0, v10
    v_sub_f32 v204, 0, v10
    v_sub_f32 v205, 0, v10
    v_sub_f32 v206, 0, v10
    v_sub_f32 v207, 0, v10
mid_kernel_nochg8:
    v_exp_f32 v96, v96
    v_exp_f32 v97, v97
    s_waitcnt lgkmcnt(8)
    v_mfma_f32_32x32x16_bf16 v[64:79], v[32:35], v[24:27], v[192:207]
    v_exp_f32 v98, v98
    v_exp_f32 v99, v99
    v_exp_f32 v100, v100
    v_mfma_f32_32x32x16_bf16 v[64:79], v[36:39], v[28:31], v[64:79]
    v_exp_f32 v101, v101
    v_exp_f32 v102, v102
    v_exp_f32 v103, v103
    v_mfma_f32_32x32x16_bf16 v[80:95], v[40:43], v[24:27], v[192:207]
    v_exp_f32 v104, v104
    v_exp_f32 v105, v105
    v_exp_f32 v106, v106
    v_mfma_f32_32x32x16_bf16 v[80:95], v[44:47], v[28:31], v[80:95]
    v_exp_f32 v107, v107
    v_exp_f32 v108, v108
    v_exp_f32 v109, v109
    s_waitcnt lgkmcnt(0)
    v_mfma_f32_32x32x16_bf16 v[160:175], v[48:51], v[128:131], v[160:175]
    v_exp_f32 v110, v110
    v_exp_f32 v111, v111
    v_cvt_pk_bf16_f32 v144, v96, v97
    v_mfma_f32_32x32x16_bf16 v[176:191], v[20:23], v[128:131], v[176:191]
    v_cvt_pk_bf16_f32 v145, v98, v99
    v_cvt_pk_bf16_f32 v146, v100, v101
    v_cvt_pk_bf16_f32 v147, v102, v103
    v_mfma_f32_32x32x16_bf16 v[160:175], v[52:55], v[132:135], v[160:175]
    v_exp_f32 v112, v112
    v_exp_f32 v113, v113
    v_exp_f32 v114, v114
    v_mfma_f32_32x32x16_bf16 v[176:191], v[20:23], v[132:135], v[176:191]
    v_exp_f32 v115, v115
    v_exp_f32 v116, v116
    v_exp_f32 v117, v117
    v_mfma_f32_32x32x16_bf16 v[160:175], v[56:59], v[136:139], v[160:175]
    v_exp_f32 v118, v118
    v_exp_f32 v119, v119
    v_cvt_pk_bf16_f32 v148, v104, v105
    v_mfma_f32_32x32x16_bf16 v[176:191], v[20:23], v[136:139], v[176:191]
    v_cvt_pk_bf16_f32 v149, v106, v107
    v_cvt_pk_bf16_f32 v150, v108, v109
    v_cvt_pk_bf16_f32 v151, v110, v111
    v_mfma_f32_32x32x16_bf16 v[160:175], v[60:63], v[140:143], v[160:175]
    v_exp_f32 v120, v120
    v_exp_f32 v121, v121
    v_exp_f32 v122, v122
    v_mfma_f32_32x32x16_bf16 v[176:191], v[20:23], v[140:143], v[176:191]
    v_exp_f32 v123, v123
    v_exp_f32 v124, v124
    v_exp_f32 v125, v125
    v_exp_f32 v126, v126
    v_exp_f32 v127, v127
    v_cvt_pk_bf16_f32 v152, v112, v113
    v_cvt_pk_bf16_f32 v153, v114, v115
    v_cvt_pk_bf16_f32 v154, v116, v117
    v_cvt_pk_bf16_f32 v155, v118, v119
    v_cvt_pk_bf16_f32 v156, v120, v121
    v_cvt_pk_bf16_f32 v157, v122, v123
    v_cvt_pk_bf16_f32 v158, v124, v125
    v_cvt_pk_bf16_f32 v159, v126, v127
    s_waitcnt vmcnt(4)
    s_barrier
    ds_read_b128 v[32:35], v4 offset:12288
    ds_read_b128 v[36:39], v5 offset:12288
    ds_read_b128 v[40:43], v4 offset:14336
    ds_read_b128 v[44:47], v5 offset:14336
    ds_read_b64_tr_b16 v[48:49], v6 offset:4096
    ds_read_b64_tr_b16 v[50:51], v6 offset:4608
    ds_read_b64_tr_b16 v[52:53], v6 offset:5120
    ds_read_b64_tr_b16 v[54:55], v6 offset:5632
    ds_read_b64_tr_b16 v[56:57], v6 offset:6144
    ds_read_b64_tr_b16 v[58:59], v6 offset:6656
    ds_read_b64_tr_b16 v[60:61], v6 offset:7168
    ds_read_b64_tr_b16 v[62:63], v6 offset:7680
    s_add_u32 m0, s44, 8192
    s_nop 0
    buffer_load_dwordx4 v2, s[8:11], s40 offen lds
    s_add_u32 s40, s40, 393216
    s_add_u32 m0, s44, 16384
    s_nop 0
    buffer_load_dwordx4 v3, s[8:11], s41 offen lds
    s_add_u32 s41, s41, 393216
    s_cmp_eq_u64 s[34:35], 0
    s_cbranch_scc1 mid_kernel_skip9
    v_mul_f32 v160, v160, v17
    v_mul_f32 v161, v161, v17
    v_mul_f32 v162, v162, v17
    v_mul_f32 v163, v163, v17
    v_mul_f32 v164, v164, v17
    v_mul_f32 v165, v165, v17
    v_mul_f32 v166, v166, v17
    v_mul_f32 v167, v167, v17
    v_mul_f32 v168, v168, v17
    v_mul_f32 v169, v169, v17
    v_mul_f32 v170, v170, v17
    v_mul_f32 v171, v171, v17
    v_mul_f32 v172, v172, v17
    v_mul_f32 v173, v173, v17
    v_mul_f32 v174, v174, v17
    v_mul_f32 v175, v175, v17
    v_mul_f32 v176, v176, v17
mid_kernel_skip9:
    v_max3_f32 v11, v64, v65, v66
    v_max3_f32 v9, v79, v80, v81
    v_max3_f32 v11, v11, v67, v68
    v_max3_f32 v9, v9, v82, v83
    v_max3_f32 v11, v11, v69, v70
    v_max3_f32 v9, v9, v84, v85
    v_max3_f32 v11, v11, v71, v72
    v_max3_f32 v9, v9, v86, v87
    v_max3_f32 v11, v11, v73, v74
    v_max3_f32 v9, v9, v88, v89
    v_max3_f32 v11, v11, v75, v76
    v_max3_f32 v9, v9, v90, v91
    v_max3_f32 v11, v11, v77, v78
    v_max3_f32 v9, v9, v92, v93
    v_max3_f32 v9, v9, v94, v95
    v_max_f32 v11, v11, v9
    v_mov_b32 v9, v11
    s_nop 1
    v_permlane32_swap_b32 v11, v9
    v_max_f32 v11, v11, v9
    v_cmp_lt_f32 s[34:35], s31, v11
    v_max_f32 v11, 0, v11
    s_cmp_eq_u64 s[34:35], 0
    s_cbranch_scc1 mid_kernel_nochg10
    v_sub_f32 v64, v64, v11
    v_sub_f32 v65, v65, v11
    v_sub_f32 v66, v66, v11
    v_sub_f32 v67, v67, v11
    v_sub_f32 v68, v68, v11
    v_sub_f32 v69, v69, v11
    v_sub_f32 v70, v70, v11
    v_sub_f32 v71, v71, v11
    v_sub_f32 v72, v72, v11
    v_sub_f32 v73, v73, v11
    v_sub_f32 v74, v74, v11
    v_sub_f32 v75, v75, v11
    v_sub_f32 v76, v76, v11
    v_sub_f32 v77, v77, v11
    v_sub_f32 v78, v78, v11
    v_sub_f32 v79, v79, v11
    v_sub_f32 v80, v80, v11
    v_sub_f32 v81, v81, v11
    v_sub_f32 v82, v82, v11
    v_sub_f32 v83, v83, v11
    v_sub_f32 v84, v84, v11
    v_sub_f32 v85, v85, v11
    v_sub_f32 v86, v86, v11
    v_sub_f32 v87, v87, v11
    v_sub_f32 v88, v88, v11
    v_sub_f32 v89, v89, v11
    v_sub_f32 v90, v90, v11
    v_sub_f32 v91, v91, v11
    v_sub_f32 v92, v92, v11
    v_sub_f32 v93, v93, v11
    v_sub_f32 v94, v94, v11
    v_sub_f32 v95, v95, v11
    v_add_f32 v10, v10, v11
    v_exp_f32 v17, -v11
    v_sub_f32 v192, 0, v10
    v_sub_f32 v193, 0, v10
    v_sub_f32 v194, 0, v10
    v_sub_f32 v195, 0, v10
    v_sub_f32 v196, 0, v10
    v_sub_f32 v197, 0, v10
    v_sub_f32 v198, 0, v10
    v_sub_f32 v199, 0, v10
    v_sub_f32 v200, 0, v10
    v_sub_f32 v201, 0, v10
    v_sub_f32 v202, 0, v10
    v_sub_f32 v203, 0, v10
    v_sub_f32 v204, 0, v10
    v_sub_f32 v205, 0, v10
    v_sub_f32 v206, 0, v10
    v_sub_f32 v207, 0, v10
mid_kernel_nochg10:
    v_exp_f32 v64, v64
    v_exp_f32 v65, v65
    s_waitcnt lgkmcnt(8)
    v_mfma_f32_32x32x16_bf16 v[96:111], v[32:35], v[24:27], v[192:207]
    v_exp_f32 v66, v66
    v_exp_f32 v67, v67
    v_exp_f32 v68, v68
    v_mfma_f32_32x32x16_bf16 v[96:111], v[36:39], v[28:31], v[96:111]
    v_exp_f32 v69, v69
    v_exp_f32 v70, v70
    v_exp_f32 v71, v71
    v_mfma_f32_32x32x16_bf16 v[112:127], v[40:43], v[24:27], v[192:207]
    v_exp_f32 v72, v72
    v_exp_f32 v73, v73
    v_exp_f32 v74, v74
    v_mfma_f32_32x32x16_bf16 v[112:127], v[44:47], v[28:31], v[112:127]
    v_exp_f32 v75, v75
    v_exp_f32 v76, v76
    v_exp_f32 v77, v77
    s_waitcnt lgkmcnt(0)
    v_mfma_f32_32x32x16_bf16 v[160:175], v[48:51], v[144:147], v[160:175]
    v_exp_f32 v78, v78
    v_exp_f32 v79, v79
    v_cvt_pk_bf16_f32 v128, v64, v65
    v_mfma_f32_32x32x16_bf16 v[176:191], v[20:23], v[144:147], v[176:191]
    v_cvt_pk_bf16_f32 v129, v66, v67
    v_cvt_pk_bf16_f32 v130, v68, v69
    v_cvt_pk_bf16_f32 v131, v70, v71
    v_mfma_f32_32x32x16_bf16 v[160:175], v[52:55], v[148:151], v[160:175]
    v_exp_f32 v80, v80
    v_exp_f32 v81, v81
    v_exp_f32 v82, v82
    v_mfma_f32_32x32x16_bf16 v[176:191], v[20:23], v[148:151], v[176:191]
    v_exp_f32 v83, v83
    v_exp_f32 v84, v84
    v_exp_f32 v85, v85
    v_mfma_f32_32x32x16_bf16 v[160:175], v[56:59], v[152:155], v[160:175]
    v_exp_f32 v86, v86
    v_exp_f32 v87, v87
    v_cvt_pk_bf16_f32 v132, v72, v73
    v_mfma_f32_32x32x16_bf16 v[176:191], v[20:23], v[152:155], v[176:191]
    v_cvt_pk_bf16_f32 v133, v74, v75
    v_cvt_pk_bf16_f32 v134, v76, v77
    v_cvt_pk_bf16_f32 v135, v78, v79
    v_mfma_f32_32x32x16_bf16 v[160:175], v[60:63], v[156:159], v[160:175]
    v_exp_f32 v88, v88
    v_exp_f32 v89, v89
    v_exp_f32 v90, v90
    v_mfma_f32_32x32x16_bf16 v[176:191], v[20:23], v[156:159], v[176:191]
    v_exp_f32 v91, v91
    v_exp_f32 v92, v92
    v_exp_f32 v93, v93
    v_exp_f32 v94, v94
    v_exp_f32 v95, v95
    v_cvt_pk_bf16_f32 v136, v80, v81
    v_cvt_pk_bf16_f32 v137, v82, v83
    v_cvt_pk_bf16_f32 v138, v84, v85
    v_cvt_pk_bf16_f32 v139, v86, v87
    v_cvt_pk_bf16_f32 v140, v88, v89
    v_cvt_pk_bf16_f32 v141, v90, v91
    v_cvt_pk_bf16_f32 v142, v92, v93
    v_cvt_pk_bf16_f32 v143, v94, v95
    s_waitcnt vmcnt(4)
    s_barrier
    ds_read_b128 v[32:35], v4 offset:0
    ds_read_b128 v[36:39], v5 offset:0
    ds_read_b128 v[40:43], v4 offset:2048
    ds_read_b128 v[44:47], v5 offset:2048
    ds_read_b64_tr_b16 v[48:49], v6 offset:8192
    ds_read_b64_tr_b16 v[50:51], v6 offset:8704
    ds_read_b64_tr_b16 v[52:53], v6 offset:9216
    ds_read_b64_tr_b16 v[54:55], v6 offset:9728
    ds_read_b64_tr_b16 v[56:57], v6 offset:10240
    ds_read_b64_tr_b16 v[58:59], v6 offset:10752
    ds_read_b64_tr_b16 v[60:61], v6 offset:11264
    ds_read_b64_tr_b16 v[62:63], v6 offset:11776
    s_add_u32 m0, s44, 12288
    s_nop 0
    buffer_load_dwordx4 v2, s[8:11], s40 offen lds
    s_add_u32 s40, s40, 393216
    s_add_u32 m0, s44, 20480
    s_nop 0
    buffer_load_dwordx4 v3, s[8:11], s41 offen lds
    s_add_u32 s41, s41, 393216
    s_cmp_eq_u64 s[34:35], 0
    s_cbranch_scc1 mid_kernel_skip11
    v_mul_f32 v160, v160, v17
    v_mul_f32 v161, v161, v17
    v_mul_f32 v162, v162, v17
    v_mul_f32 v163, v163, v17
    v_mul_f32 v164, v164, v17
    v_mul_f32 v165, v165, v17
    v_mul_f32 v166, v166, v17
    v_mul_f32 v167, v167, v17
    v_mul_f32 v168, v168, v17
    v_mul_f32 v169, v169, v17
    v_mul_f32 v170, v170, v17
    v_mul_f32 v171, v171, v17
    v_mul_f32 v172, v172, v17
    v_mul_f32 v173, v173, v17
    v_mul_f32 v174, v174, v17
    v_mul_f32 v175, v175, v17
    v_mul_f32 v176, v176, v17
mid_kernel_skip11:
    v_max3_f32 v11, v96, v97, v98
    v_max3_f32 v9, v111, v112, v113
    v_max3_f32 v11, v11, v99, v100
    v_max3_f32 v9, v9, v114, v115
    v_max3_f32 v11, v11, v101, v102
    v_max3_f32 v9, v9, v116, v117
    v_max3_f32 v11, v11, v103, v104
    v_max3_f32 v9, v9, v118, v119
    v_max3_f32 v11, v11, v105, v106
    v_max3_f32 v9, v9, v120, v121
    v_max3_f32 v11, v11, v107, v108
    v_max3_f32 v9, v9, v122, v123
    v_max3_f32 v11, v11, v109, v110
    v_max3_f32 v9, v9, v124, v125
    v_max3_f32 v9, v9, v126, v127
    v_max_f32 v11, v11, v9
    v_mov_b32 v9, v11
    s_nop 1
    v_permlane32_swap_b32 v11, v9
    v_max_f32 v11, v11, v9
    v_cmp_lt_f32 s[34:35], s31, v11
    v_max_f32 v11, 0, v11
    s_cmp_eq_u64 s[34:35], 0
    s_cbranch_scc1 mid_kernel_nochg12
    v_sub_f32 v96, v96, v11
    v_sub_f32 v97, v97, v11
    v_sub_f32 v98, v98, v11
    v_sub_f32 v99, v99, v11
    v_sub_f32 v100, v100, v11
    v_sub_f32 v101, v101, v11
    v_sub_f32 v102, v102, v11
    v_sub_f32 v103, v103, v11
    v_sub_f32 v104, v104, v11
    v_sub_f32 v105, v105, v11
    v_sub_f32 v106, v106, v11
    v_sub_f32 v107, v107, v11
    v_sub_f32 v108, v108, v11
    v_sub_f32 v109, v109, v11
    v_sub_f32 v110, v110, v11
    v_sub_f32 v111, v111, v11
    v_sub_f32 v112, v112, v11
    v_sub_f32 v113, v113, v11
    v_sub_f32 v114, v114, v11
    v_sub_f32 v115, v115, v11
    v_sub_f32 v116, v116, v11
    v_sub_f32 v117, v117, v11
    v_sub_f32 v118, v118, v11
    v_sub_f32 v119, v119, v11
    v_sub_f32 v120, v120, v11
    v_sub_f32 v121, v121, v11
    v_sub_f32 v122, v122, v11
    v_sub_f32 v123, v123, v11
    v_sub_f32 v124, v124, v11
    v_sub_f32 v125, v125, v11
    v_sub_f32 v126, v126, v11
    v_sub_f32 v127, v127, v11
    v_add_f32 v10, v10, v11
    v_exp_f32 v17, -v11
    v_sub_f32 v192, 0, v10
    v_sub_f32 v193, 0, v10
    v_sub_f32 v194, 0, v10
    v_sub_f32 v195, 0, v10
    v_sub_f32 v196, 0, v10
    v_sub_f32 v197, 0, v10
    v_sub_f32 v198, 0, v10
    v_sub_f32 v199, 0, v10
    v_sub_f32 v200, 0, v10
    v_sub_f32 v201, 0, v10
    v_sub_f32 v202, 0, v10
    v_sub_f32 v203, 0, v10
    v_sub_f32 v204, 0, v10
    v_sub_f32 v205, 0, v10
    v_sub_f32 v206, 0, v10
    v_sub_f32 v207, 0, v10
mid_kernel_nochg12:
    v_exp_f32 v96, v96
    v_exp_f32 v97, v97
    s_waitcnt lgkmcnt(8)
    v_mfma_f32_32x32x16_bf16 v[64:79], v[32:35], v[24:27], v[192:207]
    v_exp_f32 v98, v98
    v_exp_f32 v99, v99
    v_exp_f32 v100, v100
    v_mfma_f32_32x32x16_bf16 v[64:79], v[36:39], v[28:31], v[64:79]
    v_exp_f32 v101, v101
    v_exp_f32 v102, v102
    v_exp_f32 v103, v103
    v_mfma_f32_32x32x16_bf16 v[80:95], v[40:43], v[24:27], v[192:207]
    v_exp_f32 v104, v104
    v_exp_f32 v105, v105
    v_exp_f32 v106, v106
    v_mfma_f32_32x32x16_bf16 v[80:95], v[44:47], v[28:31], v[80:95]
    v_exp_f32 v107, v107
    v_exp_f32 v108, v108
    v_exp_f32 v109, v109
    s_waitcnt lgkmcnt(0)
    v_mfma_f32_32x32x16_bf16 v[160:175], v[48:51], v[128:131], v[160:175]
    v_exp_f32 v110, v110
    v_exp_f32 v111, v111
    v_cvt_pk_bf16_f32 v144, v96, v97
    v_mfma_f32_32x32x16_bf16 v[176:191], v[20:23], v[128:131], v[176:191]
    v_cvt_pk_bf16_f32 v145, v98, v99
    v_cvt_pk_bf16_f32 v146, v100, v101
    v_cvt_pk_bf16_f32 v147, v102, v103
    v_mfma_f32_32x32x16_bf16 v[160:175], v[52:55], v[132:135], v[160:175]
    v_exp_f32 v112, v112
    v_exp_f32 v113, v113
    v_exp_f32 v114, v114
    v_mfma_f32_32x32x16_bf16 v[176:191], v[20:23], v[132:135], v[176:191]
    v_exp_f32 v115, v115
    v_exp_f32 v116, v116
    v_exp_f32 v117, v117
    v_mfma_f32_32x32x16_bf16 v[160:175], v[56:59], v[136:139], v[160:175]
    v_exp_f32 v118, v118
    v_exp_f32 v119, v119
    v_cvt_pk_bf16_f32 v148, v104, v105
    v_mfma_f32_32x32x16_bf16 v[176:191], v[20:23], v[136:139], v[176:191]
    v_cvt_pk_bf16_f32 v149, v106, v107
    v_cvt_pk_bf16_f32 v150, v108, v109
    v_cvt_pk_bf16_f32 v151, v110, v111
    v_mfma_f32_32x32x16_bf16 v[160:175], v[60:63], v[140:143], v[160:175]
    v_exp_f32 v120, v120
    v_exp_f32 v121, v121
    v_exp_f32 v122, v122
    v_mfma_f32_32x32x16_bf16 v[176:191], v[20:23], v[140:143], v[176:191]
    v_exp_f32 v123, v123
    v_exp_f32 v124, v124
    v_exp_f32 v125, v125
    v_exp_f32 v126, v126
    v_exp_f32 v127, v127
    v_cvt_pk_bf16_f32 v152, v112, v113
    v_cvt_pk_bf16_f32 v153, v114, v115
    v_cvt_pk_bf16_f32 v154, v116, v117
    v_cvt_pk_bf16_f32 v155, v118, v119
    v_cvt_pk_bf16_f32 v156, v120, v121
    v_cvt_pk_bf16_f32 v157, v122, v123
    v_cvt_pk_bf16_f32 v158, v124, v125
    v_cvt_pk_bf16_f32 v159, v126, v127
    s_waitcnt vmcnt(4)
    s_barrier
    ds_read_b128 v[32:35], v4 offset:4096
    ds_read_b128 v[36:39], v5 offset:4096
    ds_read_b128 v[40:43], v4 offset:6144
    ds_read_b128 v[44:47], v5 offset:6144
    ds_read_b64_tr_b16 v[48:49], v6 offset:12288
    ds_read_b64_tr_b16 v[50:51], v6 offset:12800
    ds_read_b64_tr_b16 v[52:53], v6 offset:13312
    ds_read_b64_tr_b16 v[54:55], v6 offset:13824
    ds_read_b64_tr_b16 v[56:57], v6 offset:14336
    ds_read_b64_tr_b16 v[58:59], v6 offset:14848
    ds_read_b64_tr_b16 v[60:61], v6 offset:15360
    ds_read_b64_tr_b16 v[62:63], v6 offset:15872
    s_add_u32 m0, s44, 0
    s_nop 0
    buffer_load_dwordx4 v2, s[8:11], s40 offen lds
    s_add_u32 s40, s40, 393216
    s_add_u32 m0, s44, 24576
    s_nop 0
    buffer_load_dwordx4 v3, s[8:11], s41 offen lds
    s_add_u32 s41, s41, 393216
    s_cmp_eq_u64 s[34:35], 0
    s_cbranch_scc1 mid_kernel_skip13
    v_mul_f32 v160, v160, v17
    v_mul_f32 v161, v161, v17
    v_mul_f32 v162, v162, v17
    v_mul_f32 v163, v163, v17
    v_mul_f32 v164, v164, v17
    v_mul_f32 v165, v165, v17
    v_mul_f32 v166, v166, v17
    v_mul_f32 v167, v167, v17
    v_mul_f32 v168, v168, v17
    v_mul_f32 v169, v169, v17
    v_mul_f32 v170, v170, v17
    v_mul_f32 v171, v171, v17
    v_mul_f32 v172, v172, v17
    v_mul_f32 v173, v173, v17
    v_mul_f32 v174, v174, v17
    v_mul_f32 v175, v175, v17
    v_mul_f32 v176, v176, v17
mid_kernel_skip13:
    v_max3_f32 v11, v64, v65, v66
    v_max3_f32 v9, v79, v80, v81
    v_max3_f32 v11, v11, v67, v68
    v_max3_f32 v9, v9, v82, v83
    v_max3_f32 v11, v11, v69, v70
    v_max3_f32 v9, v9, v84, v85
    v_max3_f32 v11, v11, v71, v72
    v_max3_f32 v9, v9, v86, v87
    v_max3_f32 v11, v11, v73, v74
    v_max3_f32 v9, v9, v88, v89
    v_max3_f32 v11, v11, v75, v76
    v_max3_f32 v9, v9, v90, v91
    v_max3_f32 v11, v11, v77, v78
    v_max3_f32 v9, v9, v92, v93
    v_max3_f32 v9, v9, v94, v95
    v_max_f32 v11, v11, v9
    v_mov_b32 v9, v11
    s_nop 1
    v_permlane32_swap_b32 v11, v9
    v_max_f32 v11, v11, v9
    v_cmp_lt_f32 s[34:35], s31, v11
    v_max_f32 v11, 0, v11
    s_cmp_eq_u64 s[34:35], 0
    s_cbranch_scc1 mid_kernel_nochg14
    v_sub_f32 v64, v64, v11
    v_sub_f32 v65, v65, v11
    v_sub_f32 v66, v66, v11
    v_sub_f32 v67, v67, v11
    v_sub_f32 v68, v68, v11
    v_sub_f32 v69, v69, v11
    v_sub_f32 v70, v70, v11
    v_sub_f32 v71, v71, v11
    v_sub_f32 v72, v72, v11
    v_sub_f32 v73, v73, v11
    v_sub_f32 v74, v74, v11
    v_sub_f32 v75, v75, v11
    v_sub_f32 v76, v76, v11
    v_sub_f32 v77, v77, v11
    v_sub_f32 v78, v78, v11
    v_sub_f32 v79, v79, v11
    v_sub_f32 v80, v80, v11
    v_sub_f32 v81, v81, v11
    v_sub_f32 v82, v82, v11
    v_sub_f32 v83, v83, v11
    v_sub_f32 v84, v84, v11
    v_sub_f32 v85, v85, v11
    v_sub_f32 v86, v86, v11
    v_sub_f32 v87, v87, v11
    v_sub_f32 v88, v88, v11
    v_sub_f32 v89, v89, v11
    v_sub_f32 v90, v90, v11
    v_sub_f32 v91, v91, v11
    v_sub_f32 v92, v92, v11
    v_sub_f32 v93, v93, v11
    v_sub_f32 v94, v94, v11
    v_sub_f32 v95, v95, v11
    v_add_f32 v10, v10, v11
    v_exp_f32 v17, -v11
    v_sub_f32 v192, 0, v10
    v_sub_f32 v193, 0, v10
    v_sub_f32 v194, 0, v10
    v_sub_f32 v195, 0, v10
    v_sub_f32 v196, 0, v10
    v_sub_f32 v197, 0, v10
    v_sub_f32 v198, 0, v10
    v_sub_f32 v199, 0, v10
    v_sub_f32 v200, 0, v10
    v_sub_f32 v201, 0, v10
    v_sub_f32 v202, 0, v10
    v_sub_f32 v203, 0, v10
    v_sub_f32 v204, 0, v10
    v_sub_f32 v205, 0, v10
    v_sub_f32 v206, 0, v10
    v_sub_f32 v207, 0, v10
mid_kernel_nochg14:
    v_exp_f32 v64, v64
    v_exp_f32 v65, v65
    s_waitcnt lgkmcnt(8)
    v_mfma_f32_32x32x16_bf16 v[96:111], v[32:35], v[24:27], v[192:207]
    v_exp_f32 v66, v66
    v_exp_f32 v67, v67
    v_exp_f32 v68, v68
    v_mfma_f32_32x32x16_bf16 v[96:111], v[36:39], v[28:31], v[96:111]
    v_exp_f32 v69, v69
    v_exp_f32 v70, v70
    v_exp_f32 v71, v71
    v_mfma_f32_32x32x16_bf16 v[112:127], v[40:43], v[24:27], v[192:207]
    v_exp_f32 v72, v72
    v_exp_f32 v73, v73
    v_exp_f32 v74, v74
    v_mfma_f32_32x32x16_bf16 v[112:127], v[44:47], v[28:31], v[112:127]
    v_exp_f32 v75, v75
    v_exp_f32 v76, v76
    v_exp_f32 v77, v77
    s_waitcnt lgkmcnt(0)
    v_mfma_f32_32x32x16_bf16 v[160:175], v[48:51], v[144:147], v[160:175]
    v_exp_f32 v78, v78
    v_exp_f32 v79, v79
    v_cvt_pk_bf16_f32 v128, v64, v65
    v_mfma_f32_32x32x16_bf16 v[176:191], v[20:23], v[144:147], v[176:191]
    v_cvt_pk_bf16_f32 v129, v66, v67
    v_cvt_pk_bf16_f32 v130, v68, v69
    v_cvt_pk_bf16_f32 v131, v70, v71
    v_mfma_f32_32x32x16_bf16 v[160:175], v[52:55], v[148:151], v[160:175]
    v_exp_f32 v80, v80
    v_exp_f32 v81, v81
    v_exp_f32 v82, v82
    v_mfma_f32_32x32x16_bf16 v[176:191], v[20:23], v[148:151], v[176:191]
    v_exp_f32 v83, v83
    v_exp_f32 v84, v84
    v_exp_f32 v85, v85
    v_mfma_f32_32x32x16_bf16 v[160:175], v[56:59], v[152:155], v[160:175]
    v_exp_f32 v86, v86
    v_exp_f32 v87, v87
    v_cvt_pk_bf16_f32 v132, v72, v73
    v_mfma_f32_32x32x16_bf16 v[176:191], v[20:23], v[152:155], v[176:191]
    v_cvt_pk_bf16_f32 v133, v74, v75
    v_cvt_pk_bf16_f32 v134, v76, v77
    v_cvt_pk_bf16_f32 v135, v78, v79
    v_mfma_f32_32x32x16_bf16 v[160:175], v[60:63], v[156:159], v[160:175]
    v_exp_f32 v88, v88
    v_exp_f32 v89, v89
    v_exp_f32 v90, v90
    v_mfma_f32_32x32x16_bf16 v[176:191], v[20:23], v[156:159], v[176:191]
    v_exp_f32 v91, v91
    v_exp_f32 v92, v92
    v_exp_f32 v93, v93
    v_exp_f32 v94, v94
    v_exp_f32 v95, v95
    v_cvt_pk_bf16_f32 v136, v80, v81
    v_cvt_pk_bf16_f32 v137, v82, v83
    v_cvt_pk_bf16_f32 v138, v84, v85
    v_cvt_pk_bf16_f32 v139, v86, v87
    v_cvt_pk_bf16_f32 v140, v88, v89
    v_cvt_pk_bf16_f32 v141, v90, v91
    v_cvt_pk_bf16_f32 v142, v92, v93
    v_cvt_pk_bf16_f32 v143, v94, v95
    s_add_u32 s45, s45, 1
    s_cmp_lt_u32 s45, 7
    s_cbranch_scc1 mid_kernel_loop6
    s_waitcnt vmcnt(4)
    s_barrier
    ds_read_b128 v[32:35], v4 offset:8192
    ds_read_b128 v[36:39], v5 offset:8192
    ds_read_b128 v[40:43], v4 offset:10240
    ds_read_b128 v[44:47], v5 offset:10240
    ds_read_b64_tr_b16 v[48:49], v6 offset:0
    ds_read_b64_tr_b16 v[50:51], v6 offset:512
    ds_read_b64_tr_b16 v[52:53], v6 offset:1024
    ds_read_b64_tr_b16 v[54:55], v6 offset:1536
    ds_read_b64_tr_b16 v[56:57], v6 offset:2048
    ds_read_b64_tr_b16 v[58:59], v6 offset:2560
    ds_read_b64_tr_b16 v[60:61], v6 offset:3072
    ds_read_b64_tr_b16 v[62:63], v6 offset:3584
    s_add_u32 m0, s44, 4096
    s_nop 0
    buffer_load_dwordx4 v2, s[8:11], s40 offen lds
    s_add_u32 s40, s40, 393216
    s_add_u32 m0, s44, 28672
    s_nop 0
    buffer_load_dwordx4 v3, s[8:11], s41 offen lds
    s_add_u32 s41, s41, 393216
    s_cmp_eq_u64 s[34:35], 0
    s_cbranch_scc1 mid_kernel_skip15
    v_mul_f32 v160, v160, v17
    v_mul_f32 v161, v161, v17
    v_mul_f32 v162, v162, v17
    v_mul_f32 v163, v163, v17
    v_mul_f32 v164, v164, v17
    v_mul_f32 v165, v165, v17
    v_mul_f32 v166, v166, v17
    v_mul_f32 v167, v167, v17
    v_mul_f32 v168, v168, v17
    v_mul_f32 v169, v169, v17
    v_mul_f32 v170, v170, v17
    v_mul_f32 v171, v171, v17
    v_mul_f32 v172, v172, v17
    v_mul_f32 v173, v173, v17
    v_mul_f32 v174, v174, v17
    v_mul_f32 v175, v175, v17
    v_mul_f32 v176, v176, v17
mid_kernel_skip15:
    v_max3_f32 v11, v96, v97, v98
    v_max3_f32 v9, v111, v112, v113
    v_max3_f32 v11, v11, v99, v100
    v_max3_f32 v9, v9, v114, v115
    v_max3_f32 v11, v11, v101, v102
    v_max3_f32 v9, v9, v116, v117
    v_max3_f32 v11, v11, v103, v104
    v_max3_f32 v9, v9, v118, v119
    v_max3_f32 v11, v11, v105, v106
    v_max3_f32 v9, v9, v120, v121
    v_max3_f32 v11, v11, v107, v108
    v_max3_f32 v9, v9, v122, v123
    v_max3_f32 v11, v11, v109, v110
    v_max3_f32 v9, v9, v124, v125
    v_max3_f32 v9, v9, v126, v127
    v_max_f32 v11, v11, v9
    v_mov_b32 v9, v11
    s_nop 1
    v_permlane32_swap_b32 v11, v9
    v_max_f32 v11, v11, v9
    v_cmp_lt_f32 s[34:35], s31, v11
    v_max_f32 v11, 0, v11
    s_cmp_eq_u64 s[34:35], 0
    s_cbranch_scc1 mid_kernel_nochg16
    v_sub_f32 v96, v96, v11
    v_sub_f32 v97, v97, v11
    v_sub_f32 v98, v98, v11
    v_sub_f32 v99, v99, v11
    v_sub_f32 v100, v100, v11
    v_sub_f32 v101, v101, v11
    v_sub_f32 v102, v102, v11
    v_sub_f32 v103, v103, v11
    v_sub_f32 v104, v104, v11
    v_sub_f32 v105, v105, v11
    v_sub_f32 v106, v106, v11
    v_sub_f32 v107, v107, v11
    v_sub_f32 v108, v108, v11
    v_sub_f32 v109, v109, v11
    v_sub_f32 v110, v110, v11
    v_sub_f32 v111, v111, v11
    v_sub_f32 v112, v112, v11
    v_sub_f32 v113, v113, v11
    v_sub_f32 v114, v114, v11
    v_sub_f32 v115, v115, v11
    v_sub_f32 v116, v116, v11
    v_sub_f32 v117, v117, v11
    v_sub_f32 v118, v118, v11
    v_sub_f32 v119, v119, v11
    v_sub_f32 v120, v120, v11
    v_sub_f32 v121, v121, v11
    v_sub_f32 v122, v122, v11
    v_sub_f32 v123, v123, v11
    v_sub_f32 v124, v124, v11
    v_sub_f32 v125, v125, v11
    v_sub_f32 v126, v126, v11
    v_sub_f32 v127, v127, v11
    v_add_f32 v10, v10, v11
    v_exp_f32 v17, -v11
    v_sub_f32 v192, 0, v10
    v_sub_f32 v193, 0, v10
    v_sub_f32 v194, 0, v10
    v_sub_f32 v195, 0, v10
    v_sub_f32 v196, 0, v10
    v_sub_f32 v197, 0, v10
    v_sub_f32 v198, 0, v10
    v_sub_f32 v199, 0, v10
    v_sub_f32 v200, 0, v10
    v_sub_f32 v201, 0, v10
    v_sub_f32 v202, 0, v10
    v_sub_f32 v203, 0, v10
    v_sub_f32 v204, 0, v10
    v_sub_f32 v205, 0, v10
    v_sub_f32 v206, 0, v10
    v_sub_f32 v207, 0, v10
mid_kernel_nochg16:
    v_exp_f32 v96, v96
    v_exp_f32 v97, v97
    s_waitcnt lgkmcnt(8)
    v_mfma_f32_32x32x16_bf16 v[64:79], v[32:35], v[24:27], v[192:207]
    v_exp_f32 v98, v98
    v_exp_f32 v99, v99
    v_exp_f32 v100, v100
    v_mfma_f32_32x32x16_bf16 v[64:79], v[36:39], v[28:31], v[64:79]
    v_exp_f32 v101, v101
    v_exp_f32 v102, v102
    v_exp_f32 v103, v103
    v_mfma_f32_32x32x16_bf16 v[80:95], v[40:43], v[24:27], v[192:207]
    v_exp_f32 v104, v104
    v_exp_f32 v105, v105
    v_exp_f32 v106, v106
    v_mfma_f32_32x32x16_bf16 v[80:95], v[44:47], v[28:31], v[80:95]
    v_exp_f32 v107, v107
    v_exp_f32 v108, v108
    v_exp_f32 v109, v109
    s_waitcnt lgkmcnt(0)
    v_mfma_f32_32x32x16_bf16 v[160:175], v[48:51], v[128:131], v[160:175]
    v_exp_f32 v110, v110
    v_exp_f32 v111, v111
    v_cvt_pk_bf16_f32 v144, v96, v97
    v_mfma_f32_32x32x16_bf16 v[176:191], v[20:23], v[128:131], v[176:191]
    v_cvt_pk_bf16_f32 v145, v98, v99
    v_cvt_pk_bf16_f32 v146, v100, v101
    v_cvt_pk_bf16_f32 v147, v102, v103
    v_mfma_f32_32x32x16_bf16 v[160:175], v[52:55], v[132:135], v[160:175]
    v_exp_f32 v112, v112
    v_exp_f32 v113, v113
    v_exp_f32 v114, v114
    v_mfma_f32_32x32x16_bf16 v[176:191], v[20:23], v[132:135], v[176:191]
    v_exp_f32 v115, v115
    v_exp_f32 v116, v116
    v_exp_f32 v117, v117
    v_mfma_f32_32x32x16_bf16 v[160:175], v[56:59], v[136:139], v[160:175]
    v_exp_f32 v118, v118
    v_exp_f32 v119, v119
    v_cvt_pk_bf16_f32 v148, v104, v105
    v_mfma_f32_32x32x16_bf16 v[176:191], v[20:23], v[136:139], v[176:191]
    v_cvt_pk_bf16_f32 v149, v106, v107
    v_cvt_pk_bf16_f32 v150, v108, v109
    v_cvt_pk_bf16_f32 v151, v110, v111
    v_mfma_f32_32x32x16_bf16 v[160:175], v[60:63], v[140:143], v[160:175]
    v_exp_f32 v120, v120
    v_exp_f32 v121, v121
    v_exp_f32 v122, v122
    v_mfma_f32_32x32x16_bf16 v[176:191], v[20:23], v[140:143], v[176:191]
    v_exp_f32 v123, v123
    v_exp_f32 v124, v124
    v_exp_f32 v125, v125
    v_exp_f32 v126, v126
    v_exp_f32 v127, v127
    v_cvt_pk_bf16_f32 v152, v112, v113
    v_cvt_pk_bf16_f32 v153, v114, v115
    v_cvt_pk_bf16_f32 v154, v116, v117
    v_cvt_pk_bf16_f32 v155, v118, v119
    v_cvt_pk_bf16_f32 v156, v120, v121
    v_cvt_pk_bf16_f32 v157, v122, v123
    v_cvt_pk_bf16_f32 v158, v124, v125
    v_cvt_pk_bf16_f32 v159, v126, v127
    s_waitcnt vmcnt(4)
    s_barrier
    ds_read_b128 v[32:35], v4 offset:12288
    ds_read_b128 v[36:39], v5 offset:12288
    ds_read_b128 v[40:43], v4 offset:14336
    ds_read_b128 v[44:47], v5 offset:14336
    ds_read_b64_tr_b16 v[48:49], v6 offset:4096
    ds_read_b64_tr_b16 v[50:51], v6 offset:4608
    ds_read_b64_tr_b16 v[52:53], v6 offset:5120
    ds_read_b64_tr_b16 v[54:55], v6 offset:5632
    ds_read_b64_tr_b16 v[56:57], v6 offset:6144
    ds_read_b64_tr_b16 v[58:59], v6 offset:6656
    ds_read_b64_tr_b16 v[60:61], v6 offset:7168
    ds_read_b64_tr_b16 v[62:63], v6 offset:7680
    s_add_u32 m0, s44, 8192
    s_nop 0
    buffer_load_dwordx4 v2, s[8:11], s40 offen lds
    s_add_u32 s40, s40, 393216
    s_add_u32 m0, s44, 16384
    s_nop 0
    buffer_load_dwordx4 v3, s[8:11], s41 offen lds
    s_add_u32 s41, s41, 393216
    s_cmp_eq_u64 s[34:35], 0
    s_cbranch_scc1 mid_kernel_skip17
    v_mul_f32 v160, v160, v17
    v_mul_f32 v161, v161, v17
    v_mul_f32 v162, v162, v17
    v_mul_f32 v163, v163, v17
    v_mul_f32 v164, v164, v17
    v_mul_f32 v165, v165, v17
    v_mul_f32 v166, v166, v17
    v_mul_f32 v167, v167, v17
    v_mul_f32 v168, v168, v17
    v_mul_f32 v169, v169, v17
    v_mul_f32 v170, v170, v17
    v_mul_f32 v171, v171, v17
    v_mul_f32 v172, v172, v17
    v_mul_f32 v173, v173, v17
    v_mul_f32 v174, v174, v17
    v_mul_f32 v175, v175, v17
    v_mul_f32 v176, v176, v17
mid_kernel_skip17:
    v_max3_f32 v11, v64, v65, v66
    v_max3_f32 v9, v79, v80, v81
    v_max3_f32 v11, v11, v67, v68
    v_max3_f32 v9, v9, v82, v83
    v_max3_f32 v11, v11, v69, v70
    v_max3_f32 v9, v9, v84, v85
    v_max3_f32 v11, v11, v71, v72
    v_max3_f32 v9, v9, v86, v87
    v_max3_f32 v11, v11, v73, v74
    v_max3_f32 v9, v9, v88, v89
    v_max3_f32 v11, v11, v75, v76
    v_max3_f32 v9, v9, v90, v91
    v_max3_f32 v11, v11, v77, v78
    v_max3_f32 v9, v9, v92, v93
    v_max3_f32 v9, v9, v94, v95
    v_max_f32 v11, v11, v9
    v_mov_b32 v9, v11
    s_nop 1
    v_permlane32_swap_b32 v11, v9
    v_max_f32 v11, v11, v9
    v_cmp_lt_f32 s[34:35], s31, v11
    v_max_f32 v11, 0, v11
    s_cmp_eq_u64 s[34:35], 0
    s_cbranch_scc1 mid_kernel_nochg18
    v_sub_f32 v64, v64, v11
    v_sub_f32 v65, v65, v11
    v_sub_f32 v66, v66, v11
    v_sub_f32 v67, v67, v11
    v_sub_f32 v68, v68, v11
    v_sub_f32 v69, v69, v11
    v_sub_f32 v70, v70, v11
    v_sub_f32 v71, v71, v11
    v_sub_f32 v72, v72, v11
    v_sub_f32 v73, v73, v11
    v_sub_f32 v74, v74, v11
    v_sub_f32 v75, v75, v11
    v_sub_f32 v76, v76, v11
    v_sub_f32 v77, v77, v11
    v_sub_f32 v78, v78, v11
    v_sub_f32 v79, v79, v11
    v_sub_f32 v80, v80, v11
    v_sub_f32 v81, v81, v11
    v_sub_f32 v82, v82, v11
    v_sub_f32 v83, v83, v11
    v_sub_f32 v84, v84, v11
    v_sub_f32 v85, v85, v11
    v_sub_f32 v86, v86, v11
    v_sub_f32 v87, v87, v11
    v_sub_f32 v88, v88, v11
    v_sub_f32 v89, v89, v11
    v_sub_f32 v90, v90, v11
    v_sub_f32 v91, v91, v11
    v_sub_f32 v92, v92, v11
    v_sub_f32 v93, v93, v11
    v_sub_f32 v94, v94, v11
    v_sub_f32 v95, v95, v11
    v_add_f32 v10, v10, v11
    v_exp_f32 v17, -v11
    v_sub_f32 v192, 0, v10
    v_sub_f32 v193, 0, v10
    v_sub_f32 v194, 0, v10
    v_sub_f32 v195, 0, v10
    v_sub_f32 v196, 0, v10
    v_sub_f32 v197, 0, v10
    v_sub_f32 v198, 0, v10
    v_sub_f32 v199, 0, v10
    v_sub_f32 v200, 0, v10
    v_sub_f32 v201, 0, v10
    v_sub_f32 v202, 0, v10
    v_sub_f32 v203, 0, v10
    v_sub_f32 v204, 0, v10
    v_sub_f32 v205, 0, v10
    v_sub_f32 v206, 0, v10
    v_sub_f32 v207, 0, v10
mid_kernel_nochg18:
    v_exp_f32 v64, v64
    v_exp_f32 v65, v65
    s_waitcnt lgkmcnt(8)
    v_mfma_f32_32x32x16_bf16 v[96:111], v[32:35], v[24:27], v[192:207]
    v_exp_f32 v66, v66
    v_exp_f32 v67, v67
    v_exp_f32 v68, v68
    v_mfma_f32_32x32x16_bf16 v[96:111], v[36:39], v[28:31], v[96:111]
    v_exp_f32 v69, v69
    v_exp_f32 v70, v70
    v_exp_f32 v71, v71
    v_mfma_f32_32x32x16_bf16 v[112:127], v[40:43], v[24:27], v[192:207]
    v_exp_f32 v72, v72
    v_exp_f32 v73, v73
    v_exp_f32 v74, v74
    v_mfma_f32_32x32x16_bf16 v[112:127], v[44:47], v[28:31], v[112:127]
    v_exp_f32 v75, v75
    v_exp_f32 v76, v76
    v_exp_f32 v77, v77
    s_waitcnt lgkmcnt(0)
    v_mfma_f32_32x32x16_bf16 v[160:175], v[48:51], v[144:147], v[160:175]
    v_exp_f32 v78, v78
    v_exp_f32 v79, v79
    v_cvt_pk_bf16_f32 v128, v64, v65
    v_mfma_f32_32x32x16_bf16 v[176:191], v[20:23], v[144:147], v[176:191]
    v_cvt_pk_bf16_f32 v129, v66, v67
    v_cvt_pk_bf16_f32 v130, v68, v69
    v_cvt_pk_bf16_f32 v131, v70, v71
    v_mfma_f32_32x32x16_bf16 v[160:175], v[52:55], v[148:151], v[160:175]
    v_exp_f32 v80, v80
    v_exp_f32 v81, v81
    v_exp_f32 v82, v82
    v_mfma_f32_32x32x16_bf16 v[176:191], v[20:23], v[148:151], v[176:191]
    v_exp_f32 v83, v83
    v_exp_f32 v84, v84
    v_exp_f32 v85, v85
    v_mfma_f32_32x32x16_bf16 v[160:175], v[56:59], v[152:155], v[160:175]
    v_exp_f32 v86, v86
    v_exp_f32 v87, v87
    v_cvt_pk_bf16_f32 v132, v72, v73
    v_mfma_f32_32x32x16_bf16 v[176:191], v[20:23], v[152:155], v[176:191]
    v_cvt_pk_bf16_f32 v133, v74, v75
    v_cvt_pk_bf16_f32 v134, v76, v77
    v_cvt_pk_bf16_f32 v135, v78, v79
    v_mfma_f32_32x32x16_bf16 v[160:175], v[60:63], v[156:159], v[160:175]
    v_exp_f32 v88, v88
    v_exp_f32 v89, v89
    v_exp_f32 v90, v90
    v_mfma_f32_32x32x16_bf16 v[176:191], v[20:23], v[156:159], v[176:191]
    v_exp_f32 v91, v91
    v_exp_f32 v92, v92
    v_exp_f32 v93, v93
    v_exp_f32 v94, v94
    v_exp_f32 v95, v95
    v_cvt_pk_bf16_f32 v136, v80, v81
    v_cvt_pk_bf16_f32 v137, v82, v83
    v_cvt_pk_bf16_f32 v138, v84, v85
    v_cvt_pk_bf16_f32 v139, v86, v87
    v_cvt_pk_bf16_f32 v140, v88, v89
    v_cvt_pk_bf16_f32 v141, v90, v91
    v_cvt_pk_bf16_f32 v142, v92, v93
    v_cvt_pk_bf16_f32 v143, v94, v95
    s_waitcnt vmcnt(4)
    s_barrier
    ds_read_b64_tr_b16 v[48:49], v6 offset:8192
    ds_read_b64_tr_b16 v[50:51], v6 offset:8704
    ds_read_b64_tr_b16 v[52:53], v6 offset:9216
    ds_read_b64_tr_b16 v[54:55], v6 offset:9728
    ds_read_b64_tr_b16 v[56:57], v6 offset:10240
    ds_read_b64_tr_b16 v[58:59], v6 offset:10752
    ds_read_b64_tr_b16 v[60:61], v6 offset:11264
    ds_read_b64_tr_b16 v[62:63], v6 offset:11776
    s_add_u32 m0, s44, 12288
    s_nop 0
    buffer_load_dwordx4 v2, s[8:11], s40 offen lds
    s_add_u32 s40, s40, 393216
    s_add_u32 m0, s44, 20480
    s_nop 0
    buffer_load_dwordx4 v3, s[8:11], s41 offen lds
    s_add_u32 s41, s41, 393216
    s_cmp_eq_u64 s[34:35], 0
    s_cbranch_scc1 mid_kernel_skip19
    v_mul_f32 v160, v160, v17
    v_mul_f32 v161, v161, v17
    v_mul_f32 v162, v162, v17
    v_mul_f32 v163, v163, v17
    v_mul_f32 v164, v164, v17
    v_mul_f32 v165, v165, v17
    v_mul_f32 v166, v166, v17
    v_mul_f32 v167, v167, v17
    v_mul_f32 v168, v168, v17
    v_mul_f32 v169, v169, v17
    v_mul_f32 v170, v170, v17
    v_mul_f32 v171, v171, v17
    v_mul_f32 v172, v172, v17
    v_mul_f32 v173, v173, v17
    v_mul_f32 v174, v174, v17
    v_mul_f32 v175, v175, v17
    v_mul_f32 v176, v176, v17
mid_kernel_skip19:
    v_max3_f32 v11, v96, v97, v98
    v_max3_f32 v9, v111, v112, v113
    v_max3_f32 v11, v11, v99, v100
    v_max3_f32 v9, v9, v114, v115
    v_max3_f32 v11, v11, v101, v102
    v_max3_f32 v9, v9, v116, v117
    v_max3_f32 v11, v11, v103, v104
    v_max3_f32 v9, v9, v118, v119
    v_max3_f32 v11, v11, v105, v106
    v_max3_f32 v9, v9, v120, v121
    v_max3_f32 v11, v11, v107, v108
    v_max3_f32 v9, v9, v122, v123
    v_max3_f32 v11, v11, v109, v110
    v_max3_f32 v9, v9, v124, v125
    v_max3_f32 v9, v9, v126, v127
    v_max_f32 v11, v11, v9
    v_mov_b32 v9, v11
    s_nop 1
    v_permlane32_swap_b32 v11, v9
    v_max_f32 v11, v11, v9
    v_cmp_lt_f32 s[34:35], s31, v11
    v_max_f32 v11, 0, v11
    s_cmp_eq_u64 s[34:35], 0
    s_cbranch_scc1 mid_kernel_nochg20
    v_sub_f32 v96, v96, v11
    v_sub_f32 v97, v97, v11
    v_sub_f32 v98, v98, v11
    v_sub_f32 v99, v99, v11
    v_sub_f32 v100, v100, v11
    v_sub_f32 v101, v101, v11
    v_sub_f32 v102, v102, v11
    v_sub_f32 v103, v103, v11
    v_sub_f32 v104, v104, v11
    v_sub_f32 v105, v105, v11
    v_sub_f32 v106, v106, v11
    v_sub_f32 v107, v107, v11
    v_sub_f32 v108, v108, v11
    v_sub_f32 v109, v109, v11
    v_sub_f32 v110, v110, v11
    v_sub_f32 v111, v111, v11
    v_sub_f32 v112, v112, v11
    v_sub_f32 v113, v113, v11
    v_sub_f32 v114, v114, v11
    v_sub_f32 v115, v115, v11
    v_sub_f32 v116, v116, v11
    v_sub_f32 v117, v117, v11
    v_sub_f32 v118, v118, v11
    v_sub_f32 v119, v119, v11
    v_sub_f32 v120, v120, v11
    v_sub_f32 v121, v121, v11
    v_sub_f32 v122, v122, v11
    v_sub_f32 v123, v123, v11
    v_sub_f32 v124, v124, v11
    v_sub_f32 v125, v125, v11
    v_sub_f32 v126, v126, v11
    v_sub_f32 v127, v127, v11
    v_add_f32 v10, v10, v11
    v_exp_f32 v17, -v11
    v_sub_f32 v192, 0, v10
    v_sub_f32 v193, 0, v10
    v_sub_f32 v194, 0, v10
    v_sub_f32 v195, 0, v10
    v_sub_f32 v196, 0, v10
    v_sub_f32 v197, 0, v10
    v_sub_f32 v198, 0, v10
    v_sub_f32 v199, 0, v10
    v_sub_f32 v200, 0, v10
    v_sub_f32 v201, 0, v10
    v_sub_f32 v202, 0, v10
    v_sub_f32 v203, 0, v10
    v_sub_f32 v204, 0, v10
    v_sub_f32 v205, 0, v10
    v_sub_f32 v206, 0, v10
    v_sub_f32 v207, 0, v10
mid_kernel_nochg20:
    v_exp_f32 v96, v96
    v_exp_f32 v97, v97
    s_waitcnt lgkmcnt(0)
    v_mfma_f32_32x32x16_bf16 v[160:175], v[48:51], v[128:131], v[160:175]
    v_exp_f32 v98, v98
    v_exp_f32 v99, v99
    v_exp_f32 v100, v100
    v_exp_f32 v101, v101
    v_exp_f32 v102, v102
    v_mfma_f32_32x32x16_bf16 v[176:191], v[20:23], v[128:131], v[176:191]
    v_exp_f32 v103, v103
    v_exp_f32 v104, v104
    v_exp_f32 v105, v105
    v_exp_f32 v106, v106
    v_exp_f32 v107, v107
    v_mfma_f32_32x32x16_bf16 v[160:175], v[52:55], v[132:135], v[160:175]
    v_exp_f32 v108, v108
    v_exp_f32 v109, v109
    v_exp_f32 v110, v110
    v_exp_f32 v111, v111
    v_cvt_pk_bf16_f32 v144, v96, v97
    v_mfma_f32_32x32x16_bf16 v[176:191], v[20:23], v[132:135], v[176:191]
    v_cvt_pk_bf16_f32 v145, v98, v99
    v_cvt_pk_bf16_f32 v146, v100, v101
    v_cvt_pk_bf16_f32 v147, v102, v103
    v_exp_f32 v112, v112
    v_exp_f32 v113, v113
    v_mfma_f32_32x32x16_bf16 v[160:175], v[56:59], v[136:139], v[160:175]
    v_exp_f32 v114, v114
    v_exp_f32 v115, v115
    v_exp_f32 v116, v116
    v_exp_f32 v117, v117
    v_exp_f32 v118, v118
    v_mfma_f32_32x32x16_bf16 v[176:191], v[20:23], v[136:139], v[176:191]
    v_exp_f32 v119, v119
    v_cvt_pk_bf16_f32 v148, v104, v105
    v_cvt_pk_bf16_f32 v149, v106, v107
    v_cvt_pk_bf16_f32 v150, v108, v109
    v_cvt_pk_bf16_f32 v151, v110, v111
    v_mfma_f32_32x32x16_bf16 v[160:175], v[60:63], v[140:143], v[160:175]
    v_exp_f32 v120, v120
    v_exp_f32 v121, v121
    v_exp_f32 v122, v122
    v_exp_f32 v123, v123
    v_exp_f32 v124, v124
    v_mfma_f32_32x32x16_bf16 v[176:191], v[20:23], v[140:143], v[176:191]
    v_exp_f32 v125, v125
    v_exp_f32 v126, v126
    v_exp_f32 v127, v127
    v_cvt_pk_bf16_f32 v152, v112, v113
    v_cvt_pk_bf16_f32 v153, v114, v115
    v_cvt_pk_bf16_f32 v154, v116, v117
    v_cvt_pk_bf16_f32 v155, v118, v119
    v_cvt_pk_bf16_f32 v156, v120, v121
    v_cvt_pk_bf16_f32 v157, v122, v123
    v_cvt_pk_bf16_f32 v158, v124, v125
    v_cvt_pk_bf16_f32 v159, v126, v127
    s_waitcnt vmcnt(4)
    s_barrier
    ds_read_b64_tr_b16 v[48:49], v6 offset:12288
    ds_read_b64_tr_b16 v[50:51], v6 offset:12800
    ds_read_b64_tr_b16 v[52:53], v6 offset:13312
    ds_read_b64_tr_b16 v[54:55], v6 offset:13824
    ds_read_b64_tr_b16 v[56:57], v6 offset:14336
    ds_read_b64_tr_b16 v[58:59], v6 offset:14848
    ds_read_b64_tr_b16 v[60:61], v6 offset:15360
    ds_read_b64_tr_b16 v[62:63], v6 offset:15872
    s_cmp_eq_u64 s[34:35], 0
    s_cbranch_scc1 mid_kernel_skip21
    v_mul_f32 v160, v160, v17
    v_mul_f32 v161, v161, v17
    v_mul_f32 v162, v162, v17
    v_mul_f32 v163, v163, v17
    v_mul_f32 v164, v164, v17
    v_mul_f32 v165, v165, v17
    v_mul_f32 v166, v166, v17
    v_mul_f32 v167, v167, v17
    v_mul_f32 v168, v168, v17
    v_mul_f32 v169, v169, v17
    v_mul_f32 v170, v170, v17
    v_mul_f32 v171, v171, v17
    v_mul_f32 v172, v172, v17
    v_mul_f32 v173, v173, v17
    v_mul_f32 v174, v174, v17
    v_mul_f32 v175, v175, v17
    v_mul_f32 v176, v176, v17
mid_kernel_skip21:
    s_waitcnt lgkmcnt(0)
    v_mfma_f32_32x32x16_bf16 v[160:175], v[48:51], v[144:147], v[160:175]
    v_mfma_f32_32x32x16_bf16 v[176:191], v[20:23], v[144:147], v[176:191]
    v_mfma_f32_32x32x16_bf16 v[160:175], v[52:55], v[148:151], v[160:175]
    v_mfma_f32_32x32x16_bf16 v[176:191], v[20:23], v[148:151], v[176:191]
    v_mfma_f32_32x32x16_bf16 v[160:175], v[56:59], v[152:155], v[160:175]
    v_mfma_f32_32x32x16_bf16 v[176:191], v[20:23], v[152:155], v[176:191]
    v_mfma_f32_32x32x16_bf16 v[160:175], v[60:63], v[156:159], v[160:175]
    v_mfma_f32_32x32x16_bf16 v[176:191], v[20:23], v[156:159], v[176:191]
mid_kernel_done4:
    s_waitcnt vmcnt(0)
    s_mov_b32 s21, 9216
    v_mul_lo_u32 v15, v14, s21
    v_add_u32 v15, s22, v15
    v_lshl_add_u32 v15, v13, 4, v15
    s_nop 7
    s_nop 7
    v_rcp_f32 v9, v176
    s_nop 0
    v_mul_f32 v160, v160, v9
    v_mul_f32 v161, v161, v9
    v_mul_f32 v162, v162, v9
    v_mul_f32 v163, v163, v9
    v_mul_f32 v164, v164, v9
    v_mul_f32 v165, v165, v9
    v_mul_f32 v166, v166, v9
    v_mul_f32 v167, v167, v9
    v_mul_f32 v168, v168, v9
    v_mul_f32 v169, v169, v9
    v_mul_f32 v170, v170, v9
    v_mul_f32 v171, v171, v9
    v_mul_f32 v172, v172, v9
    v_mul_f32 v173, v173, v9
    v_mul_f32 v174, v174, v9
    v_mul_f32 v175, v175, v9
    v_cvt_pk_bf16_f32 v160, v160, v161
    v_cvt_pk_bf16_f32 v161, v162, v163
    v_cvt_pk_bf16_f32 v162, v164, v165
    v_cvt_pk_bf16_f32 v163, v166, v167
    v_cvt_pk_bf16_f32 v164, v168, v169
    v_cvt_pk_bf16_f32 v165, v170, v171
    v_cvt_pk_bf16_f32 v166, v172, v173
    v_cvt_pk_bf16_f32 v167, v174, v175
    s_nop 1
    v_permlane32_swap_b32 v160, v162
    v_permlane32_swap_b32 v161, v163
    v_permlane32_swap_b32 v164, v166
    v_permlane32_swap_b32 v165, v167
    buffer_store_dwordx4 v[160:163], v15, s[16:19], 0 offen offset:0
    buffer_store_dwordx4 v[164:167], v15, s[16:19], 0 offen offset:32
mid_kernel_end:
    s_endpgm
.section .rodata,"a"
.p2align 6
.amdhsa_kernel mid_kernel
  .amdhsa_next_free_vgpr 208
  .amdhsa_next_free_sgpr 100
  .amdhsa_accum_offset 208
  .amdhsa_group_segment_fixed_size 0
  .amdhsa_kernarg_size 72
  .amdhsa_user_sgpr_count 2
  .amdhsa_user_sgpr_kernarg_segment_ptr 1
  .amdhsa_system_sgpr_workgroup_id_x 1
.end_amdhsa_kernel
.text
.globl final_kernel
.p2align 8
.type final_kernel,@function
final_kernel:
    s_load_dwordx16 s[64:79], s[0:1], 0
    s_load_dwordx2 s[80:81], s[0:1], 64
    s_cmp_ge_u32 s2, 256
    s_cbranch_scc1 final_kernel_end
    s_waitcnt lgkmcnt(0)
    v_lshrrev_b32 v1, 6, v0
    v_and_b32 v0, 63, v0
    s_nop 0
    v_readfirstlane_b32 s4, v1
    s_and_b32 s24, s2, 15
    s_mul_i32 s24, s24, 64
    s_lshr_b32 s23, s2, 4
    s_lshl_b32 s23, s23, 7
    s_add_u32 s8, s80, 0x1000000
    s_addc_u32 s9, s81, 0
    s_and_b32 s9, s9, 0xffff
    s_mov_b32 s10, 0x1200000
    s_mov_b32 s11, 0x00020000
    s_mov_b32 s12, s68
    s_mov_b32 s13, s69
    s_and_b32 s13, s13, 0xffff
    s_mov_b32 s14, 0x200000
    s_mov_b32 s15, 0x00020000
    s_add_u32 s28, s80, 0x2400000
    s_addc_u32 s29, s81, 0
    s_and_b32 s29, s29, 0xffff
    s_mov_b32 s30, 0x1000000
    s_mov_b32 s31, 0x00020000
    s_mov_b32 s16, s76
    s_mov_b32 s17, s77
    s_and_b32 s17, s17, 0xffff
    s_mov_b32 s18, 0x400000
    s_mov_b32 s19, 0x00020000
    s_mov_b32 s32, s64
    s_mov_b32 s33, s65
    s_and_b32 s33, s33, 0xffff
    s_mov_b32 s34, 0x400000
    s_mov_b32 s35, 0x00020000
    s_mov_b32 s20, 2048
    s_mov_b32 s21, 2048
    s_mov_b32 s25, s24
    s_mov_b32 s36, 0
    s_mov_b32 s37, 0
    s_mov_b32 s39, 8388608
    s_mov_b32 s50, 16777216
    s_mov_b32 s51, 25165824
    s_lshr_b32 s5, s4, 1
    s_and_b32 s6, s4, 1
    v_lshrrev_b32 v3, 3, v0
    s_lshl_b32 s7, s4, 3
    s_add_u32 s7, s7, s23
    v_add_u32 v3, s7, v3
    s_mov_b32 s7, 9216
    v_mul_lo_u32 v2, v3, s7
    s_and_b32 s7, s4, 1
    s_lshl_b32 s7, s7, 2
    v_lshrrev_b32 v3, 4, v0
    v_add_u32 v3, s7, v3
    v_and_b32 v3, 7, v3
    v_and_b32 v4, 7, v0
    v_xor_b32 v3, v3, v4
    v_lshl_add_u32 v2, v3, 4, v2
    v_lshrrev_b32 v4, 3, v0
    s_mul_i32 s7, s4, 8
    v_add_u32 v4, s7, v4
    v_mul_lo_u32 v3, v4, s20
    v_lshrrev_b32 v4, 1, v4
    v_and_b32 v4, 1, v4
    v_lshlrev_b32 v4, 2, v4
    v_and_b32 v5, 7, v0
    v_xor_b32 v4, v4, v5
    v_lshl_add_u32 v3, v4, 4, v3
    s_lshl_b32 s7, s24, 1
    v_add_u32 v3, s7, v3
    v_and_b32 v12, 31, v0
    v_lshrrev_b32 v13, 5, v0
    s_mul_i32 s7, s5, 8192
    v_lshlrev_b32 v14, 7, v12
    v_add_u32 v14, s7, v14
    v_lshrrev_b32 v15, 1, v0
    v_and_b32 v15, 7, v15
    v_add_u32 v16, 0, v13
    v_xor_b32 v16, v16, v15
    v_lshl_add_u32 v4, v16, 4, v14
    v_add_u32 v16, 2, v13
    v_xor_b32 v16, v16, v15
    v_lshl_add_u32 v5, v16, 4, v14
    v_add_u32 v16, 4, v13
    v_xor_b32 v16, v16, v15
    v_lshl_add_u32 v6, v16, 4, v14
    v_add_u32 v16, 6, v13
    v_xor_b32 v16, v16, v15
    v_lshl_add_u32 v7, v16, 4, v14
    v_lshrrev_b32 v14, 2, v0
    v_and_b32 v14, 3, v14
    v_lshl_add_u32 v15, v13, 3, v14
    s_mov_b32 s7, 128
    v_mul_lo_u32 v15, v15, s7
    v_lshrrev_b32 v16, 4, v0
    v_and_b32 v16, 1, v16
    v_lshl_add_u32 v15, v16, 5, v15
    v_and_b32 v16, 3, v0
    v_lshl_add_u32 v15, v16, 3, v15
    v_add_u32 v15, 16384, v15
    v_lshrrev_b32 v14, 1, v14
    s_mul_i32 s7, s6, 1
    s_add_u32 s26, s7, 0
    s_and_b32 s27, s26, 1
    v_xor_b32 v16, s27, v14
    s_andn2_b32 s26, s26, 1
    v_add_u32 v16, s26, v16
    v_lshl_add_u32 v8, v16, 6, v15
    v_mov_b32 v80, 0
    v_mov_b32 v81, 0
    v_mov_b32 v82, 0
    v_mov_b32 v83, 0
    v_mov_b32 v84, 0
    v_mov_b32 v85, 0
    v_mov_b32 v86, 0
    v_mov_b32 v87, 0
    v_mov_b32 v88, 0
    v_mov_b32 v89, 0
    v_mov_b32 v90, 0
    v_mov_b32 v91, 0
    v_mov_b32 v92, 0
    v_mov_b32 v93, 0
    v_mov_b32 v94, 0
    v_mov_b32 v95, 0
    v_mov_b32 v96, 0
    v_mov_b32 v97, 0
    v_mov_b32 v98, 0
    v_mov_b32 v99, 0
    v_mov_b32 v100, 0
    v_mov_b32 v101, 0
    v_mov_b32 v102, 0
    v_mov_b32 v103, 0
    v_mov_b32 v104, 0
    v_mov_b32 v105, 0
    v_mov_b32 v106, 0
    v_mov_b32 v107, 0
    v_mov_b32 v108, 0
    v_mov_b32 v109, 0
    v_mov_b32 v110, 0
    v_mov_b32 v111, 0
    s_mov_b32 s40, s36
    s_mov_b32 s41, s37
    s_lshl_b32 s42, s20, 6
    s_mul_i32 s43, s20, 32
    s_lshl_b32 s44, s4, 10
    s_mov_b32 s45, 0
    s_mul_i32 s7, s5, 64
    s_add_u32 s7, s7, s23
    v_add_u32 v14, s7, v12
    v_mul_lo_u32 v15, v14, s21
    s_mul_i32 s7, s6, 32
    s_add_u32 s7, s7, s25
    s_lshl_b32 s7, s7, 1
    v_add_u32 v15, s7, v15
    v_lshl_add_u32 v16, v13, 4, v15
    v_lshl_add_u32 v17, v13, 3, v15
    v_lshlrev_b32 v18, 1, v17
    s_lshl_b32 s47, s21, 5
    buffer_load_dwordx2 v[112:113], v17, s[32:35], 0 offen offset:0
    buffer_load_dwordx4 v[120:123], v18, s[28:31], 0 offen offset:0
    buffer_load_dwordx4 v[136:139], v18, s[28:31], s39 offen offset:0
    buffer_load_dwordx2 v[114:115], v17, s[32:35], 0 offen offset:16
    buffer_load_dwordx4 v[124:127], v18, s[28:31], 0 offen offset:32
    buffer_load_dwordx4 v[140:143], v18, s[28:31], s39 offen offset:32
    buffer_load_dwordx2 v[116:117], v17, s[32:35], 0 offen offset:32
    buffer_load_dwordx4 v[128:131], v18, s[28:31], 0 offen offset:64
    buffer_load_dwordx4 v[144:147], v18, s[28:31], s39 offen offset:64
    buffer_load_dwordx2 v[118:119], v17, s[32:35], 0 offen offset:48
    buffer_load_dwordx4 v[132:135], v18, s[28:31], 0 offen offset:96
    buffer_load_dwordx4 v[148:151], v18, s[28:31], s39 offen offset:96
    v_add_u32 v17, s47, v17
    v_lshlrev_b32 v18, 1, v17
    buffer_load_dwordx2 v[152:153], v17, s[32:35], 0 offen offset:0
    buffer_load_dwordx4 v[160:163], v18, s[28:31], 0 offen offset:0
    buffer_load_dwordx4 v[176:179], v18, s[28:31], s39 offen offset:0
    buffer_load_dwordx2 v[154:155], v17, s[32:35], 0 offen offset:16
    buffer_load_dwordx4 v[164:167], v18, s[28:31], 0 offen offset:32
    buffer_load_dwordx4 v[180:183], v18, s[28:31], s39 offen offset:32
    buffer_load_dwordx2 v[156:157], v17, s[32:35], 0 offen offset:32
    buffer_load_dwordx4 v[168:171], v18, s[28:31], 0 offen offset:64
    buffer_load_dwordx4 v[184:187], v18, s[28:31], s39 offen offset:64
    buffer_load_dwordx2 v[158:159], v17, s[32:35], 0 offen offset:48
    buffer_load_dwordx4 v[172:175], v18, s[28:31], 0 offen offset:96
    buffer_load_dwordx4 v[188:191], v18, s[28:31], s39 offen offset:96
    v_mov_b32 v20, v4
    v_mov_b32 v21, v5
    v_mov_b32 v22, v6
    v_mov_b32 v23, v7
    v_mov_b32 v24, v8
    s_mov_b32 s48, 0
    s_add_u32 s46, s40, 0
    s_add_u32 m0, s44, 0
    s_nop 0
    buffer_load_dwordx4 v2, s[8:11], s46 offen lds
    s_add_u32 s46, s40, 294912
    s_add_u32 m0, s44, 4096
    s_nop 0
    buffer_load_dwordx4 v2, s[8:11], s46 offen lds
    s_add_u32 s46, s40, 589824
    s_add_u32 m0, s44, 8192
    s_nop 0
    buffer_load_dwordx4 v2, s[8:11], s46 offen lds
    s_add_u32 s46, s40, 884736
    s_add_u32 m0, s44, 12288
    s_nop 0
    buffer_load_dwordx4 v2, s[8:11], s46 offen lds
    s_add_u32 m0, s44, 16384
    s_mov_b32 s49, s41
    buffer_load_dwordx4 v3, s[12:15], s49 offen lds
    s_add_u32 m0, s44, 20480
    s_add_u32 s49, s49, s43
    buffer_load_dwordx4 v3, s[12:15], s49 offen lds
    s_add_u32 s40, s40, 128
    s_add_u32 s41, s41, s42
    s_add_u32 s44, s44, 24576
    s_cmp_ge_u32 s44, 98304
    s_cselect_b32 s46, 98304, 0
    s_sub_u32 s44, s44, s46
    s_add_u32 s46, s40, 0
    s_add_u32 m0, s44, 0
    s_nop 0
    buffer_load_dwordx4 v2, s[8:11], s46 offen lds
    s_add_u32 s46, s40, 294912
    s_add_u32 m0, s44, 4096
    s_nop 0
    buffer_load_dwordx4 v2, s[8:11], s46 offen lds
    s_add_u32 s46, s40, 589824
    s_add_u32 m0, s44, 8192
    s_nop 0
    buffer_load_dwordx4 v2, s[8:11], s46 offen lds
    s_add_u32 s46, s40, 884736
    s_add_u32 m0, s44, 12288
    s_nop 0
    buffer_load_dwordx4 v2, s[8:11], s46 offen lds
    s_add_u32 m0, s44, 16384
    s_mov_b32 s49, s41
    buffer_load_dwordx4 v3, s[12:15], s49 offen lds
    s_add_u32 m0, s44, 20480
    s_add_u32 s49, s49, s43
    buffer_load_dwordx4 v3, s[12:15], s49 offen lds
    s_add_u32 s40, s40, 128
    s_add_u32 s41, s41, s42
    s_add_u32 s44, s44, 24576
    s_cmp_ge_u32 s44, 98304
    s_cselect_b32 s46, 98304, 0
    s_sub_u32 s44, s44, s46
    s_add_u32 s46, s40, 0
    s_add_u32 m0, s44, 0
    s_nop 0
    buffer_load_dwordx4 v2, s[8:11], s46 offen lds
    s_add_u32 s46, s40, 294912
    s_add_u32 m0, s44, 4096
    s_nop 0
    buffer_load_dwordx4 v2, s[8:11], s46 offen lds
    s_add_u32 s46, s40, 589824
    s_add_u32 m0, s44, 8192
    s_nop 0
    buffer_load_dwordx4 v2, s[8:11], s46 offen lds
    s_add_u32 s46, s40, 884736
    s_add_u32 m0, s44, 12288
    s_nop 0
    buffer_load_dwordx4 v2, s[8:11], s46 offen lds
    s_add_u32 m0, s44, 16384
    s_mov_b32 s49, s41
    buffer_load_dwordx4 v3, s[12:15], s49 offen lds
    s_add_u32 m0, s44, 20480
    s_add_u32 s49, s49, s43
    buffer_load_dwordx4 v3, s[12:15], s49 offen lds
    s_add_u32 s40, s40, 128
    s_add_u32 s41, s41, s42
    s_add_u32 s44, s44, 24576
    s_cmp_ge_u32 s44, 98304
    s_cselect_b32 s46, 98304, 0
    s_sub_u32 s44, s44, s46
final_kernel_loop1:
    s_waitcnt vmcnt(12)
    s_barrier
    s_add_u32 s45, s45, 1
    ds_read_b64_tr_b16 v[28:29], v8 offset:0
    ds_read_b64_tr_b16 v[30:31], v8 offset:512
    ds_read_b128 v[32:35], v4 offset:0
    ds_read_b128 v[36:39], v4 offset:4096
    ds_read_b64_tr_b16 v[40:41], v8 offset:2048
    ds_read_b64_tr_b16 v[42:43], v8 offset:2560
    ds_read_b128 v[44:47], v5 offset:0
    ds_read_b128 v[48:51], v5 offset:4096
    s_waitcnt lgkmcnt(4)
    v_mfma_f32_32x32x16_bf16 v[80:95], v[28:31], v[32:35], v[80:95]
    s_add_u32 s46, s40, 0
    s_add_u32 m0, s44, 0
    s_nop 0
    buffer_load_dwordx4 v2, s[8:11], s46 offen lds
    v_mfma_f32_32x32x16_bf16 v[96:111], v[28:31], v[36:39], v[96:111]
    s_add_u32 s46, s40, 294912
    s_add_u32 m0, s44, 4096
    s_nop 0
    buffer_load_dwordx4 v2, s[8:11], s46 offen lds
    ds_read_b64_tr_b16 v[28:29], v8 offset:4096
    ds_read_b64_tr_b16 v[30:31], v8 offset:4608
    ds_read_b128 v[32:35], v6 offset:0
    ds_read_b128 v[36:39], v6 offset:4096
    s_waitcnt lgkmcnt(4)
    v_mfma_f32_32x32x16_bf16 v[80:95], v[40:43], v[44:47], v[80:95]
    s_add_u32 s46, s40, 589824
    s_add_u32 m0, s44, 8192
    s_nop 0
    buffer_load_dwordx4 v2, s[8:11], s46 offen lds
    v_mfma_f32_32x32x16_bf16 v[96:111], v[40:43], v[48:51], v[96:111]
    s_add_u32 s46, s40, 884736
    s_add_u32 m0, s44, 12288
    s_nop 0
    buffer_load_dwordx4 v2, s[8:11], s46 offen lds
    ds_read_b64_tr_b16 v[40:41], v8 offset:6144
    ds_read_b64_tr_b16 v[42:43], v8 offset:6656
    ds_read_b128 v[44:47], v7 offset:0
    ds_read_b128 v[48:51], v7 offset:4096
    s_waitcnt lgkmcnt(4)
    v_mfma_f32_32x32x16_bf16 v[80:95], v[28:31], v[32:35], v[80:95]
    s_add_u32 m0, s44, 16384
    s_mov_b32 s49, s41
    buffer_load_dwordx4 v3, s[12:15], s49 offen lds
    v_mfma_f32_32x32x16_bf16 v[96:111], v[28:31], v[36:39], v[96:111]
    s_add_u32 m0, s44, 20480
    s_add_u32 s49, s49, s43
    buffer_load_dwordx4 v3, s[12:15], s49 offen lds
    s_add_u32 s40, s40, 128
    s_add_u32 s41, s41, s42
    s_add_u32 s44, s44, 24576
    s_cmp_ge_u32 s44, 98304
    s_cselect_b32 s46, 98304, 0
    s_sub_u32 s44, s44, s46
    s_waitcnt lgkmcnt(0)
    v_mfma_f32_32x32x16_bf16 v[80:95], v[40:43], v[44:47], v[80:95]
    v_mfma_f32_32x32x16_bf16 v[96:111], v[40:43], v[48:51], v[96:111]
    s_add_u32 s48, s48, 24576
    s_cmp_ge_u32 s48, 98304
    s_cselect_b32 s48, 0, s48
    v_add_u32 v4, s48, v20
    v_add_u32 v5, s48, v21
    v_add_u32 v6, s48, v22
    v_add_u32 v7, s48, v23
    v_add_u32 v8, s48, v24
    s_cmp_lt_u32 s45, 16
    s_cbranch_scc1 final_kernel_loop1
    s_waitcnt vmcnt(0)
    s_mul_i32 s7, s5, 64
    s_add_u32 s7, s7, s23
    v_add_u32 v14, s7, v12
    v_mul_lo_u32 v15, v14, s21
    s_mul_i32 s7, s6, 32
    s_add_u32 s7, s7, s25
    s_lshl_b32 s7, s7, 1
    v_add_u32 v15, s7, v15
    v_lshl_add_u32 v16, v13, 4, v15
    v_lshl_add_u32 v17, v13, 3, v15
    v_lshlrev_b32 v18, 1, v17
    s_lshl_b32 s47, s21, 5
    s_nop 7
    s_nop 7
    v_add_f32 v120, v120, v136
    v_add_f32 v121, v121, v137
    v_add_f32 v122, v122, v138
    v_add_f32 v123, v123, v139
    v_add_f32 v124, v124, v140
    v_add_f32 v125, v125, v141
    v_add_f32 v126, v126, v142
    v_add_f32 v127, v127, v143
    v_add_f32 v128, v128, v144
    v_add_f32 v129, v129, v145
    v_add_f32 v130, v130, v146
    v_add_f32 v131, v131, v147
    v_add_f32 v132, v132, v148
    v_add_f32 v133, v133, v149
    v_add_f32 v134, v134, v150
    v_add_f32 v135, v135, v151
    v_lshlrev_b32 v136, 16, v112
    v_and_b32 v137, 0xffff0000, v112
    v_lshlrev_b32 v138, 16, v113
    v_and_b32 v139, 0xffff0000, v113
    v_lshlrev_b32 v140, 16, v114
    v_and_b32 v141, 0xffff0000, v114
    v_lshlrev_b32 v142, 16, v115
    v_and_b32 v143, 0xffff0000, v115
    v_lshlrev_b32 v144, 16, v116
    v_and_b32 v145, 0xffff0000, v116
    v_lshlrev_b32 v146, 16, v117
    v_and_b32 v147, 0xffff0000, v117
    v_lshlrev_b32 v148, 16, v118
    v_and_b32 v149, 0xffff0000, v118
    v_lshlrev_b32 v150, 16, v119
    v_and_b32 v151, 0xffff0000, v119
    v_add_f32 v80, v80, v136
    v_add_f32 v80, v80, v120
    v_add_f32 v81, v81, v137
    v_add_f32 v81, v81, v121
    v_add_f32 v82, v82, v138
    v_add_f32 v82, v82, v122
    v_add_f32 v83, v83, v139
    v_add_f32 v83, v83, v123
    v_add_f32 v84, v84, v140
    v_add_f32 v84, v84, v124
    v_add_f32 v85, v85, v141
    v_add_f32 v85, v85, v125
    v_add_f32 v86, v86, v142
    v_add_f32 v86, v86, v126
    v_add_f32 v87, v87, v143
    v_add_f32 v87, v87, v127
    v_add_f32 v88, v88, v144
    v_add_f32 v88, v88, v128
    v_add_f32 v89, v89, v145
    v_add_f32 v89, v89, v129
    v_add_f32 v90, v90, v146
    v_add_f32 v90, v90, v130
    v_add_f32 v91, v91, v147
    v_add_f32 v91, v91, v131
    v_add_f32 v92, v92, v148
    v_add_f32 v92, v92, v132
    v_add_f32 v93, v93, v149
    v_add_f32 v93, v93, v133
    v_add_f32 v94, v94, v150
    v_add_f32 v94, v94, v134
    v_add_f32 v95, v95, v151
    v_add_f32 v95, v95, v135
    v_cvt_pk_bf16_f32 v80, v80, v81
    v_cvt_pk_bf16_f32 v81, v82, v83
    v_cvt_pk_bf16_f32 v82, v84, v85
    v_cvt_pk_bf16_f32 v83, v86, v87
    v_cvt_pk_bf16_f32 v84, v88, v89
    v_cvt_pk_bf16_f32 v85, v90, v91
    v_cvt_pk_bf16_f32 v86, v92, v93
    v_cvt_pk_bf16_f32 v87, v94, v95
    s_nop 1
    v_permlane32_swap_b32 v80, v82
    v_permlane32_swap_b32 v81, v83
    v_permlane32_swap_b32 v84, v86
    v_permlane32_swap_b32 v85, v87
    buffer_store_dwordx4 v[80:83], v16, s[16:19], 0 offen offset:0
    buffer_store_dwordx4 v[84:87], v16, s[16:19], 0 offen offset:32
    v_add_u32 v16, s47, v16
    v_add_u32 v17, s47, v17
    v_lshlrev_b32 v18, 1, v17
    v_add_f32 v160, v160, v176
    v_add_f32 v161, v161, v177
    v_add_f32 v162, v162, v178
    v_add_f32 v163, v163, v179
    v_add_f32 v164, v164, v180
    v_add_f32 v165, v165, v181
    v_add_f32 v166, v166, v182
    v_add_f32 v167, v167, v183
    v_add_f32 v168, v168, v184
    v_add_f32 v169, v169, v185
    v_add_f32 v170, v170, v186
    v_add_f32 v171, v171, v187
    v_add_f32 v172, v172, v188
    v_add_f32 v173, v173, v189
    v_add_f32 v174, v174, v190
    v_add_f32 v175, v175, v191
    v_lshlrev_b32 v176, 16, v152
    v_and_b32 v177, 0xffff0000, v152
    v_lshlrev_b32 v178, 16, v153
    v_and_b32 v179, 0xffff0000, v153
    v_lshlrev_b32 v180, 16, v154
    v_and_b32 v181, 0xffff0000, v154
    v_lshlrev_b32 v182, 16, v155
    v_and_b32 v183, 0xffff0000, v155
    v_lshlrev_b32 v184, 16, v156
    v_and_b32 v185, 0xffff0000, v156
    v_lshlrev_b32 v186, 16, v157
    v_and_b32 v187, 0xffff0000, v157
    v_lshlrev_b32 v188, 16, v158
    v_and_b32 v189, 0xffff0000, v158
    v_lshlrev_b32 v190, 16, v159
    v_and_b32 v191, 0xffff0000, v159
    v_add_f32 v96, v96, v176
    v_add_f32 v96, v96, v160
    v_add_f32 v97, v97, v177
    v_add_f32 v97, v97, v161
    v_add_f32 v98, v98, v178
    v_add_f32 v98, v98, v162
    v_add_f32 v99, v99, v179
    v_add_f32 v99, v99, v163
    v_add_f32 v100, v100, v180
    v_add_f32 v100, v100, v164
    v_add_f32 v101, v101, v181
    v_add_f32 v101, v101, v165
    v_add_f32 v102, v102, v182
    v_add_f32 v102, v102, v166
    v_add_f32 v103, v103, v183
    v_add_f32 v103, v103, v167
    v_add_f32 v104, v104, v184
    v_add_f32 v104, v104, v168
    v_add_f32 v105, v105, v185
    v_add_f32 v105, v105, v169
    v_add_f32 v106, v106, v186
    v_add_f32 v106, v106, v170
    v_add_f32 v107, v107, v187
    v_add_f32 v107, v107, v171
    v_add_f32 v108, v108, v188
    v_add_f32 v108, v108, v172
    v_add_f32 v109, v109, v189
    v_add_f32 v109, v109, v173
    v_add_f32 v110, v110, v190
    v_add_f32 v110, v110, v174
    v_add_f32 v111, v111, v191
    v_add_f32 v111, v111, v175
    v_cvt_pk_bf16_f32 v96, v96, v97
    v_cvt_pk_bf16_f32 v97, v98, v99
    v_cvt_pk_bf16_f32 v98, v100, v101
    v_cvt_pk_bf16_f32 v99, v102, v103
    v_cvt_pk_bf16_f32 v100, v104, v105
    v_cvt_pk_bf16_f32 v101, v106, v107
    v_cvt_pk_bf16_f32 v102, v108, v109
    v_cvt_pk_bf16_f32 v103, v110, v111
    s_nop 1
    v_permlane32_swap_b32 v96, v98
    v_permlane32_swap_b32 v97, v99
    v_permlane32_swap_b32 v100, v102
    v_permlane32_swap_b32 v101, v103
    buffer_store_dwordx4 v[96:99], v16, s[16:19], 0 offen offset:0
    buffer_store_dwordx4 v[100:103], v16, s[16:19], 0 offen offset:32
final_kernel_end:
    s_endpgm
.section .rodata,"a"
.p2align 6
.amdhsa_kernel final_kernel
  .amdhsa_next_free_vgpr 192
  .amdhsa_next_free_sgpr 100
  .amdhsa_accum_offset 192
  .amdhsa_group_segment_fixed_size 0
  .amdhsa_kernarg_size 72
  .amdhsa_user_sgpr_count 2
  .amdhsa_user_sgpr_kernarg_segment_ptr 1
  .amdhsa_system_sgpr_workgroup_id_x 1
.end_amdhsa_kernel
```
